```python
import torch

def _softmax(x, axis=-1):
    return torch.softmax(x, dim=axis)
def _gelu(x):
    return torch.nn.functional.gelu(x, approximate="tanh")
def _silu(x):
    return torch.nn.functional.silu(x)
def _sigmoid(x):
    return torch.sigmoid(x)
def _layernorm(x, axis=-1, eps=1e-5):
    m = x.mean(dim=axis, keepdim=True)
    v = x.var(dim=axis, keepdim=True, unbiased=False)
    return (x - m) / torch.sqrt(v + eps)
def _scatter_add(tgt, idx, src, axis=0):
    return tgt.clone().index_add_(axis, idx, src)
def _segment_sum(src, seg, n):
    out = torch.zeros((n,) + src.shape[1:], dtype=src.dtype)
    return out.index_add_(0, seg, src)
def _pad(x, pw):
    flat = tuple(v for pair in reversed(pw) for v in pair)
    return torch.nn.functional.pad(x, flat)

kernel_name = 'recurrent_scan__compressed_kv_cla__geglu_ffn__decode'

def setup_inputs():

    _w = (lambda a: (lambda t: t.to(torch.bfloat16) if t.is_floating_point() else t)(torch.as_tensor(a)))
    def _A_setup():
        B, H, Sq, Sk, D, M = 1, 32, 1, 16384, 128, 512
        Dc = 4 * D
        return {
            "x": _w((lambda *s: torch.randn(*s, dtype=torch.bfloat16) * 0.05)(B, Sq, M)),
            "c_kv": _w((lambda *s: torch.randn(*s, dtype=torch.bfloat16) * 0.8)(B, Sk, Dc)),
            "w_q": _w((lambda *s: torch.randn(*s, dtype=torch.bfloat16) * 1.6)(M, H, D) * (M ** -0.5)),
            "w_uk": _w((lambda *s: torch.randn(*s, dtype=torch.bfloat16) * 1.6)(Dc, H, D) * (Dc ** -0.5)),
            "w_uv": _w((lambda *s: torch.randn(*s, dtype=torch.bfloat16) * 0.8)(Dc, H, D) * (Dc ** -0.5)),
            "w_o": _w((lambda *s: torch.randn(*s, dtype=torch.bfloat16) * 0.8)(H, D, M) * ((H * D) ** -0.5)),
        }
    _A_in = _A_setup()

    def _B_setup():
        B, S, D, F = 1, 1, 512, 1792
        return {
            "x": _w((lambda *s: torch.randn(*s, dtype=torch.bfloat16) * 0.05)(B, S, D)),
            "w_gate": _w((lambda *s: torch.randn(*s, dtype=torch.bfloat16) * 0.2)(D, F)),
            "w_up": _w((lambda *s: torch.randn(*s, dtype=torch.bfloat16) * 0.2)(D, F)),
            "w_down": _w((lambda *s: torch.randn(*s, dtype=torch.bfloat16) * 0.2)(F, D)),
        }
    _B_in = _B_setup()

    return {
        "A_x": _A_in["x"],
        "A_c_kv": _A_in["c_kv"],
        "A_w_q": _A_in["w_q"],
        "A_w_uk": _A_in["w_uk"],
        "A_w_uv": _A_in["w_uv"],
        "A_w_o": _A_in["w_o"],
        "B_x": _B_in["x"],
        "B_w_gate": _B_in["w_gate"],
        "B_w_up": _B_in["w_up"],
        "B_w_down": _B_in["w_down"],
    }

def reference(A_x, A_c_kv, A_w_q, A_w_uk, A_w_uv, A_w_o, B_x, B_w_gate, B_w_up, B_w_down):
    def _A_ref(x, c_kv, w_q, w_uk, w_uv, w_o):
        B, Sq, M = x.shape[0], x.shape[1], x.shape[2]
        Sk = c_kv.shape[1]
        H, D = w_q.shape[1], w_q.shape[2]
        q = torch.einsum("bqm,mhd->bhqd", x, w_q)
        k = torch.einsum("bkc,chd->bhkd", c_kv, w_uk)
        v = torch.einsum("bkc,chd->bhkd", c_kv, w_uv)
        scores = torch.einsum("bhqd,bhkd->bhqk", q, k) * (D ** -0.5)
        off = Sk - Sq
        qi = torch.arange(Sq)[:, None]
        kj = torch.arange(Sk)[None, :]
        cmask = kj <= (qi + off)
        scores = torch.where(cmask[None, None], scores, -1e9)
        p = _softmax(scores, axis=-1)
        ctx = torch.einsum("bhqk,bhkd->bhqd", p, v)
        return torch.einsum("bhqd,hdm->bqm", ctx, w_o)

    def _B_ref(x, w_gate, w_up, w_down):
        return (_gelu(x @ w_gate) * (x @ w_up)) @ w_down

    x = A_x
    xn = _layernorm(x, axis=-1)
    s = _A_ref(xn, A_c_kv, A_w_q, A_w_uk, A_w_uv, A_w_o)
    g = _silu(_B_ref(xn, B_w_gate, B_w_up, B_w_down))
    return x + s * g
```

```asm
; @launch grid=(256,1,1) block=(512,1,1) lds=162736
.amdgcn_target "amdgcn-amd-amdhsa--gfx950"
.text
.globl recurrent_scan__compressed_kv_cla__geglu_ffn__decode_kernel
.p2align 8
.type recurrent_scan__compressed_kv_cla__geglu_ffn__decode_kernel,@function
recurrent_scan__compressed_kv_cla__geglu_ffn__decode_kernel:
    s_cmpk_gt_u32 s2, 255
    s_cbranch_scc1 L_end
    s_load_dwordx16 s[16:31], s[0:1], 0
    s_load_dwordx8 s[32:39], s[0:1], 64
    s_load_dwordx2 s[40:41], s[0:1], 96
    v_lshrrev_b32 v14, 6, v0
    v_and_b32 v1, 63, v0
    v_readfirstlane_b32 s3, v14
    v_mov_b32 v7, 0x20000
    v_and_b32 v2, 15, v1
    v_mov_b32 v44, 0
    v_mov_b32 v45, 0xff800000
    v_lshl_add_u32 v49, v2, 2, v7
    ds_write_b32 v49, v44 offset:31232
    ds_write_b32 v49, v45 offset:31296
    s_and_b32 s5, s2, 7
    s_lshr_b32 s6, s2, 3
    s_lshr_b32 s7, s2, 7
    s_bfe_u32 s14, s2, 0x10006
    s_lshl1_add_u32 s14, s5, s14
    s_lshl4_add_u32 s8, s7, s14
    s_bfe_u32 s9, s2, 0x10005
    s_lshl1_add_u32 s46, s8, s9
    s_lshl_b32 s46, s46, 7
    s_and_b32 s4, s3, 3
    v_lshrrev_b32 v4, 3, v1
    v_and_b32 v5, 7, v1
    v_lshlrev_b32 v16, 13, v4
    v_lshl_or_b32 v16, v5, 4, v16
    v_lshlrev_b32 v6, 4, v1
    s_mov_b32 s55, 0x10000
    s_and_b32 s10, s6, 3
    s_lshl_b32 s14, s4, 20
    s_add_u32 s14, s14, s46
    v_add_u32 v17, s14, v16
    s_lshl_b32 s42, s10, 18
    v_add_u32 v18, s42, v17
    v_lshrrev_b32 v3, 4, v1
    v_mov_b32 v12, 1
    s_and_b32 s13, s6, 15
    s_lshl_b32 s11, s7, 2
    s_xor_b32 s11, s11, s13
    s_lshl4_add_u32 s11, s5, s11
    s_xor_b32 s12, s7, 1
    s_mov_b32 s53, 0x2000000
    s_mov_b32 s54, 0x40000
    s_getpc_b64 s[58:59]
L_pc:
    s_lshl3_add_u32 s43, s6, s3
    s_lshl_b32 s43, s43, 6
    s_min_u32 s43, s43, L_code_end-L_pc-4
    s_cmp_lg_u32 s3, 0
    s_waitcnt lgkmcnt(0)
    s_cbranch_scc1 L_nox
    global_load_dwordx4 v[52:55], v6, s[16:17]
L_nox:
    s_load_dword s97, s[58:59], s43
    s_barrier
    s_cmp_lt_u32 s3, 4
    s_cbranch_scc1 L_stream
    s_setprio 3
    global_load_dwordx4 v[64:67], v18, s[20:21]
    v_add_u32 v18, s55, v18
    global_load_dwordx4 v[68:71], v18, s[20:21]
    v_add_u32 v18, s55, v18
    global_load_dwordx4 v[72:75], v18, s[20:21]
    v_add_u32 v18, s55, v18
    global_load_dwordx4 v[76:79], v18, s[20:21]
    s_add_u32 s42, s42, 0x40000
    s_and_b32 s42, s42, 0xc0000
    s_lshl2_add_u32 s15, s10, s4
    s_lshl_b32 s15, s15, 18
    s_add_u32 s15, s15, s46
    v_lshlrev_b32 v19, 4, v4
    v_xor_b32 v19, v19, v16
    v_add_u32 v19, s15, v19
    s_lshl_b32 s15, s4, 12
    s_add_u32 m0, s15, 0x20000
    s_nop 0
    global_load_lds_dwordx4 v19, s[22:23] offset:0
    v_add_u32 v19, 64512, v19
    global_load_lds_dwordx4 v19, s[22:23] offset:1024
    v_add_u32 v19, 64512, v19
    global_load_lds_dwordx4 v19, s[22:23] offset:2048
    v_add_u32 v19, 64512, v19
    global_load_lds_dwordx4 v19, s[22:23] offset:3072
    s_mov_b64 exec, 1
    ds_add_u32 v7, v12 offset:31272
    s_mov_b64 exec, -1
    s_lshl_b32 s14, s46, 3
    s_lshl2_add_u32 s15, s10, s4
    s_lshl_b32 s15, s15, 6
    s_add_u32 s14, s14, s15
    s_add_u32 s14, s14, 0x10000
    v_lshl_add_u32 v25, v3, 4, s14
    v_add_u32 v18, s42, v17
    global_load_dwordx4 v[80:83], v18, s[20:21]
    v_add_u32 v18, s55, v18
    global_load_dwordx4 v[84:87], v18, s[20:21]
    v_add_u32 v18, s55, v18
    global_load_dwordx4 v[88:91], v18, s[20:21]
    v_add_u32 v18, s55, v18
    global_load_dwordx4 v[92:95], v18, s[20:21]
    s_add_u32 s42, s42, 0x40000
    s_and_b32 s42, s42, 0xc0000
    v_add_u32 v18, s42, v17
    global_load_dwordx4 v[96:99], v18, s[20:21]
    v_add_u32 v18, s55, v18
    global_load_dwordx4 v[100:103], v18, s[20:21]
    v_add_u32 v18, s55, v18
    global_load_dwordx4 v[104:107], v18, s[20:21]
    v_add_u32 v18, s55, v18
    global_load_dwordx4 v[108:111], v18, s[20:21]
    s_add_u32 s42, s42, 0x40000
    s_and_b32 s42, s42, 0xc0000
    v_add_u32 v18, s42, v17
    global_load_dwordx4 v[112:115], v18, s[20:21]
    v_add_u32 v18, s55, v18
    global_load_dwordx4 v[116:119], v18, s[20:21]
    v_add_u32 v18, s55, v18
    global_load_dwordx4 v[120:123], v18, s[20:21]
    v_add_u32 v18, s55, v18
    global_load_dwordx4 v[124:127], v18, s[20:21]
    s_branch L_front
L_stream:
    s_cmp_lg_u32 s4, 0
    s_cbranch_scc1 L_sprep
    s_setprio 3
    s_load_dword s98, s[40:41], 0
    v_add_u32 v48, v7, v6
    v_lshlrev_b32 v35, 9, v3
    v_add_u32 v35, v49, v35
    s_waitcnt vmcnt(0)
L_xok:
    v_lshlrev_b32 v24, 16, v52
    v_and_b32 v25, 0xffff0000, v52
    v_lshlrev_b32 v26, 16, v53
    v_and_b32 v27, 0xffff0000, v53
    v_lshlrev_b32 v28, 16, v54
    v_and_b32 v29, 0xffff0000, v54
    v_lshlrev_b32 v30, 16, v55
    v_and_b32 v31, 0xffff0000, v55
    v_pk_add_f32 v[32:33], v[24:25], v[26:27]
    v_pk_add_f32 v[36:37], v[28:29], v[30:31]
    v_pk_add_f32 v[32:33], v[32:33], v[36:37]
    v_add_f32 v32, v32, v33
    ds_write_b128 v48, v[52:55] offset:22784
    s_nop 0
    v_add_f32_dpp v32, v32, v32 row_ror:8 row_mask:0xf bank_mask:0xf
    s_nop 1
    v_add_f32_dpp v32, v32, v32 row_ror:4 row_mask:0xf bank_mask:0xf
    s_nop 1
    v_add_f32_dpp v32, v32, v32 row_ror:2 row_mask:0xf bank_mask:0xf
    s_nop 1
    v_add_f32_dpp v32, v32, v32 row_ror:1 row_mask:0xf bank_mask:0xf
    v_mov_b32 v33, v32
    s_nop 1
    v_permlane16_swap_b32 v32, v33
    v_add_f32 v32, v32, v33
    v_mov_b32 v33, v32
    s_nop 1
    v_permlane32_swap_b32 v32, v33
    v_add_f32 v32, v32, v33
    v_mul_f32 v32, 0x3b000000, v32
    v_sub_f32 v36, v24, v32
    v_sub_f32 v37, v25, v32
    v_sub_f32 v38, v26, v32
    v_sub_f32 v39, v27, v32
    v_sub_f32 v40, v28, v32
    v_sub_f32 v41, v29, v32
    v_sub_f32 v42, v30, v32
    v_sub_f32 v43, v31, v32
    v_cvt_pk_bf16_f32 v32, v32, v32
    v_and_b32 v32, 0xffff0000, v32
    v_mul_f32 v34, v36, v36
    v_mul_f32 v33, v37, v37
    v_fmac_f32 v34, v38, v38
    v_fmac_f32 v33, v39, v39
    v_fmac_f32 v34, v40, v40
    v_fmac_f32 v33, v41, v41
    v_fmac_f32 v34, v42, v42
    v_fmac_f32 v33, v43, v43
    v_add_f32 v34, v34, v33
    v_sub_f32 v24, v24, v32
    v_sub_f32 v25, v25, v32
    v_add_f32_dpp v34, v34, v34 row_ror:8 row_mask:0xf bank_mask:0xf
    v_sub_f32 v26, v26, v32
    v_sub_f32 v27, v27, v32
    v_add_f32_dpp v34, v34, v34 row_ror:4 row_mask:0xf bank_mask:0xf
    v_sub_f32 v28, v28, v32
    v_sub_f32 v29, v29, v32
    v_add_f32_dpp v34, v34, v34 row_ror:2 row_mask:0xf bank_mask:0xf
    v_sub_f32 v30, v30, v32
    v_sub_f32 v31, v31, v32
    v_add_f32_dpp v34, v34, v34 row_ror:1 row_mask:0xf bank_mask:0xf
    v_mov_b32 v33, v34
    v_cvt_pk_bf16_f32 v25, v24, v25
    v_cvt_pk_bf16_f32 v27, v26, v27
    v_permlane16_swap_b32 v34, v33
    v_add_f32 v34, v34, v33
    v_mov_b32 v33, v34
    v_cvt_pk_bf16_f32 v29, v28, v29
    v_cvt_pk_bf16_f32 v31, v30, v31
    v_permlane32_swap_b32 v34, v33
    v_add_f32 v34, v34, v33
    v_mul_f32 v34, 0x3b000000, v34
    v_cvt_pk_bf16_f32 v34, v34, v34
    v_and_b32 v34, 0xffff0000, v34
    v_add_f32 v34, 0x3727c5ac, v34
    v_cvt_pk_bf16_f32 v34, v34, v34
    v_and_b32 v34, 0xffff0000, v34
    v_sqrt_f32 v34, v34
    v_lshlrev_b32 v24, 16, v25
    v_and_b32 v25, 0xffff0000, v25
    v_cvt_pk_bf16_f32 v34, v34, v34
    v_and_b32 v34, 0xffff0000, v34
    v_rcp_f32 v34, v34
    v_lshlrev_b32 v26, 16, v27
    v_and_b32 v27, 0xffff0000, v27
    v_lshlrev_b32 v28, 16, v29
    v_and_b32 v29, 0xffff0000, v29
    v_lshlrev_b32 v30, 16, v31
    v_and_b32 v31, 0xffff0000, v31
    v_mul_f32 v24, v24, v34
    v_mul_f32 v25, v25, v34
    v_mul_f32 v26, v26, v34
    v_mul_f32 v27, v27, v34
    v_mul_f32 v28, v28, v34
    v_mul_f32 v29, v29, v34
    v_mul_f32 v30, v30, v34
    v_mul_f32 v31, v31, v34
    v_cvt_pk_bf16_f32 v24, v24, v24
    ds_write_b32 v35, v24 offset:20736
    v_cvt_pk_bf16_f32 v25, v25, v25
    ds_write_b32 v35, v25 offset:20800
    v_cvt_pk_bf16_f32 v26, v26, v26
    ds_write_b32 v35, v26 offset:20864
    v_cvt_pk_bf16_f32 v27, v27, v27
    ds_write_b32 v35, v27 offset:20928
    v_cvt_pk_bf16_f32 v28, v28, v28
    ds_write_b32 v35, v28 offset:20992
    v_cvt_pk_bf16_f32 v29, v29, v29
    ds_write_b32 v35, v29 offset:21056
    v_cvt_pk_bf16_f32 v30, v30, v30
    ds_write_b32 v35, v30 offset:21120
    v_cvt_pk_bf16_f32 v31, v31, v31
    ds_write_b32 v35, v31 offset:21184
    s_waitcnt lgkmcnt(0)
    v_mov_b32 v14, s98
    ds_write_b32 v7, v14 offset:31648
    s_mov_b64 exec, 1
    ds_add_u32 v7, v12 offset:31268
    s_mov_b64 exec, -1
    s_setprio 1
    s_branch L_sprep2
L_sprep:
L_sprep2:
    v_and_b32 v14, 1, v5
    v_lshlrev_b32 v14, 4, v14
    v_mov_b32 v15, 0xffff
    v_lshlrev_b32 v14, v14, v15
    v_lshrrev_b32 v15, 1, v5
    v_cmp_eq_u32 vcc, 0, v15
    v_cmp_eq_u32 s[92:93], 1, v15
    v_cmp_eq_u32 s[94:95], 2, v15
    v_cndmask_b32 v8, 0, v14, vcc
    v_cmp_eq_u32 vcc, 3, v15
    v_cndmask_b32 v9, 0, v14, s[92:93]
    v_cndmask_b32 v10, 0, v14, s[94:95]
    v_cndmask_b32 v11, 0, v14, vcc
    s_mov_b32 s92, 0x00ff00ff
    s_mov_b32 s93, 0xff00ff00
    s_lshl_b32 s14, s4, 18
    s_lshl_b32 s15, s2, 6
    s_add_u32 s14, s14, s15
    s_add_u32 s14, s14, 0x60000
    v_lshlrev_b32 v18, 14, v2
    v_lshl_or_b32 v18, v3, 4, v18
    v_add_u32 v18, s14, v18
    s_and_b32 s14, s4, 1
    s_lshr_b32 s15, s4, 1
    s_lshl3_add_u32 s14, s14, s15
    s_lshl_b32 s14, s14, 4
    v_xor_b32 v44, s14, v6
    v_xor_b32 v45, 32, v44
    v_xor_b32 v46, 64, v44
    v_xor_b32 v47, 0x60, v44
    s_lshl_b32 s14, s11, 17
    s_lshl_b32 s15, s4, 12
    s_add_u32 s14, s14, s15
    s_add_u32 s56, s18, s14
    s_addc_u32 s57, s19, 0
    s_mov_b32 m0, s15
L_spin_1:
    ds_read_b32 v13, v7 offset:31272
    s_waitcnt lgkmcnt(0)
    v_readfirstlane_b32 s14, v13
    s_nop 0
    s_cmp_ge_u32 s14, 4
    s_cbranch_scc1 L_spind_2
    s_sleep 1
    s_sub_u32 s53, s53, 1
    s_cbranch_scc0 L_spin_1
    s_mov_b32 s53, 0
L_spind_2:
    global_load_lds_dwordx4 v44, s[56:57] offset:0
    global_load_lds_dwordx4 v45, s[56:57] offset:1024
    global_load_lds_dwordx4 v46, s[56:57] offset:2048
    global_load_lds_dwordx4 v47, s[56:57] offset:3072
    s_add_u32 s56, s56, 0x4000
    s_addc_u32 s57, s57, 0
    s_add_u32 m0, m0, 0x4000
    s_nop 0
    global_load_lds_dwordx4 v44, s[56:57] offset:0
    global_load_lds_dwordx4 v45, s[56:57] offset:1024
    global_load_lds_dwordx4 v46, s[56:57] offset:2048
    global_load_lds_dwordx4 v47, s[56:57] offset:3072
    s_add_u32 s56, s56, 0x4000
    s_addc_u32 s57, s57, 0
    s_add_u32 m0, m0, 0x4000
    v_mov_b32 v53, 0xff
    s_lshr_b32 s14, s5, 1
    s_lshl2_add_u32 s14, s7, s14
    s_mul_i32 s43, s14, 28
    s_and_b32 s14, s5, 1
    s_mul_i32 s15, s14, 12
    s_add_u32 s43, s43, s15
    s_add_u32 s43, s43, s13
    s_lshl2_add_u32 s14, s14, 12
    s_cmp_lt_u32 s13, s14
    s_cselect_b32 s96, -1, 0
    s_lshr_b32 s47, s43, 3
    s_and_b32 s99, s43, 7
    s_lshr_b32 s15, s4, 1
    s_lshl1_add_u32 s14, s99, s15
    s_mul_i32 s14, s14, 114688
    s_lshl_b32 s15, s47, 7
    s_add_u32 s14, s14, s15
    v_mul_u32_u24 v14, 3584, v4
    v_lshl_add_u32 v14, v5, 4, v14
    v_add_u32 v200, s14, v14
    v_and_b32 v200, s96, v200
    v_add_u32 v201, 28672, v200
    v_add_u32 v202, 57344, v200
    v_add_u32 v203, 86016, v200
    v_lshlrev_b32 v17, 10, v3
    v_lshl_or_b32 v17, v2, 4, v17
    s_lshl_b32 s15, s4, 8
    s_add_u32 s15, s15, 0x1000
    s_lshl_b32 s14, s46, 9
    s_add_u32 s14, s14, s15
    v_add_u32 v14, s14, v17
    s_lshl_b32 s44, s10, 14
    v_add_u32 v209, s44, v14
    s_add_u32 s44, s44, 0x2000
    s_and_b32 s44, s44, 0xe000
    v_add_u32 v210, s44, v14
    s_add_u32 s44, s44, 0x2000
    s_and_b32 s44, s44, 0xe000
    v_add_u32 v211, s44, v14
    s_add_u32 s44, s44, 0x2000
    s_and_b32 s44, s44, 0xe000
    v_add_u32 v212, s44, v14
    s_add_u32 s44, s44, 0x2000
    s_and_b32 s44, s44, 0xe000
    v_add_u32 v213, s44, v14
    s_add_u32 s44, s44, 0x2000
    s_and_b32 s44, s44, 0xe000
    v_add_u32 v214, s44, v14
    s_add_u32 s44, s44, 0x2000
    s_and_b32 s44, s44, 0xe000
    v_add_u32 v215, s44, v14
    s_add_u32 s44, s44, 0x2000
    s_and_b32 s44, s44, 0xe000
    v_add_u32 v216, s44, v14
    s_lshl_b32 s14, s43, 13
    s_add_u32 s14, s14, s15
    v_add_u32 v255, s14, v17
    v_and_b32 v255, s96, v255
    v_or_b32 v255, 0x1000, v255
    s_lshr_b32 s14, s4, 1
    s_lshl_b32 s14, s14, 5
    s_lshl2_add_u32 s14, s10, s14
    s_and_b32 s15, s4, 1
    s_add_u32 s14, s14, s15
    s_lshl_b32 s14, s14, 16
    s_add_u32 s14, s14, s46
    v_add_u32 v217, s14, v16
    v_add_u32 v218, 0x20000, v217
    v_add_u32 v219, 0x100000, v217
    v_add_u32 v254, 0x120000, v217
    global_load_lds_dwordx4 v44, s[56:57] offset:0
    global_load_lds_dwordx4 v45, s[56:57] offset:1024
    global_load_lds_dwordx4 v46, s[56:57] offset:2048
    global_load_lds_dwordx4 v47, s[56:57] offset:3072
    s_add_u32 s56, s56, 0x4000
    s_addc_u32 s57, s57, 0
    s_add_u32 m0, m0, 0x4000
    s_lshr_b32 s14, s99, 1
    s_lshl_b32 s14, s14, 9
    s_and_b32 s15, s99, 1
    s_lshl_b32 s15, s15, 5
    s_add_u32 s14, s14, s15
    s_lshr_b32 s15, s4, 1
    s_lshl4_add_u32 s14, s15, s14
    s_add_u32 s14, s14, 0x25100
    v_lshl_add_u32 v15, v4, 6, s14
L_spin_3:
    ds_read_b32 v13, v7 offset:31268
    ds_read_b32 v14, v7 offset:31648
    ds_read_b128 v[24:27], v15
    s_waitcnt lgkmcnt(0)
    v_readfirstlane_b32 s14, v13
    s_nop 0
    s_cmp_ge_u32 s14, 1
    s_cbranch_scc1 L_spind_4
    s_sub_u32 s53, s53, 1
    s_cbranch_scc0 L_spin_3
    s_mov_b32 s53, 0
L_spind_4:
    v_readfirstlane_b32 s52, v14
    s_nop 0
    s_add_u32 s52, s52, 0x01010101
    s_cmp_eq_u32 s52, 0
    s_cselect_b32 s52, 0x01010101, s52
    s_and_b32 s48, s52, 0xff
    s_bfe_u32 s49, s52, 0x80008
    s_bfe_u32 s50, s52, 0x80010
    s_lshr_b32 s51, s52, 24
    s_lshl2_add_u32 s14, s13, s4
    s_cmp_lg_u32 s14, 1
    s_cbranch_scc1 L_noinit
    s_lshl3_add_u32 s14, s12, s5
    s_lshl_b32 s14, s14, 8
    s_add_u32 s14, s14, 0x1000
    v_lshl_add_u32 v14, v1, 13, s14
    v_and_b32 v15, 1, v1
    v_sub_u32 v15, s52, v15
    s_mov_b64 exec, 15
    global_store_dword v14, v15, s[40:41] sc1
    s_mov_b64 exec, -1
L_noinit:
    v_and_b32 v168, v24, v8
    v_and_b32 v169, v24, v9
    v_and_b32 v170, v24, v10
    v_and_b32 v171, v24, v11
    v_and_b32 v172, v25, v8
    v_and_b32 v173, v25, v9
    v_and_b32 v174, v25, v10
    v_and_b32 v175, v25, v11
    v_and_b32 v176, v26, v8
    v_and_b32 v177, v26, v9
    v_and_b32 v178, v26, v10
    v_and_b32 v179, v26, v11
    v_and_b32 v180, v27, v8
    v_and_b32 v181, v27, v9
    v_and_b32 v182, v27, v10
    v_and_b32 v183, v27, v11
    v_and_b32 v32, 1, v3
    v_lshlrev_b32 v32, 4, v32
    v_lshl_or_b32 v32, v5, 5, v32
    v_lshrrev_b32 v15, 5, v1
    v_lshl_or_b32 v32, v15, 8, v32
    s_lshl_b32 s14, s4, 9
    s_add_u32 s14, s14, 0x25d00
    v_add_u32 v32, s14, v32
    s_and_b32 s14, s4, 1
    s_lshr_b32 s15, s4, 1
    s_lshl1_add_u32 s14, s14, s15
    s_sub_u32 s14, s14, s4
    s_lshl_b32 s14, s14, 9
    v_add_u32 v33, s14, v32
    v_bfe_u32 v36, v1, 2, 3
    v_lshlrev_b32 v34, 5, v36
    v_and_b32 v35, 1, v1
    v_lshl_or_b32 v34, v35, 4, v34
    v_bfe_u32 v35, v1, 1, 1
    v_lshl_or_b32 v34, v35, 10, v34
    v_add_u32 v34, v7, v34
    s_lshl_b32 s14, s47, 12
    s_lshl_b32 s15, s99, 6
    s_add_u32 s14, s14, s15
    s_add_u32 s14, s14, 0x38000
    v_lshlrev_b32 v36, 9, v36
    v_and_b32 v19, 3, v1
    v_lshl_or_b32 v19, v19, 4, v36
    v_add_u32 v19, s14, v19
    global_load_lds_dwordx4 v44, s[56:57] offset:0
    global_load_lds_dwordx4 v45, s[56:57] offset:1024
    global_load_lds_dwordx4 v46, s[56:57] offset:2048
    global_load_lds_dwordx4 v47, s[56:57] offset:3072
    s_add_u32 s56, s56, 0x4000
    s_addc_u32 s57, s57, 0
    s_add_u32 m0, m0, 0x4000
    v_mov_b32 v184, 0
    v_mov_b32 v185, 0
    v_mov_b32 v186, 0
    v_mov_b32 v187, 0
    v_mov_b32 v188, 0
    v_mov_b32 v189, 0
    v_mov_b32 v190, 0
    v_mov_b32 v191, 0
    v_mov_b32 v192, 0
    v_mov_b32 v193, 0
    v_mov_b32 v194, 0
    v_mov_b32 v195, 0
    v_mov_b32 v196, 0
    v_mov_b32 v197, 0
    v_mov_b32 v198, 0
    v_mov_b32 v199, 0
    v_mov_b32 v52, 0
    s_lshl_b32 s14, s4, 7
    s_add_u32 s14, s14, 0x26500
    v_lshl_add_u32 v54, v4, 4, s14
    s_lshl_b32 s14, s10, 2
    v_add_u32 v55, s14, v2
    v_and_b32 v55, 15, v55
    v_lshl_add_u32 v55, v55, 2, v3
    v_lshlrev_b32 v55, 2, v55
    v_add_u32 v55, 0x25d00, v55
    s_and_b32 s44, s6, 7
    s_lshl3_add_u32 s44, s5, s44
    s_lshl_b32 s14, s44, 14
    s_lshl_b32 s15, s4, 12
    s_add_u32 s14, s14, s15
    s_add_u32 s14, s14, 0x60000
    v_add_u32 v60, s14, v6
    v_and_b32 v61, 3, v1
    v_lshl_add_u32 v61, v3, 2, v61
    v_lshlrev_b32 v61, 4, v61
    s_lshl_b32 s14, s4, 8
    s_add_u32 s14, s14, 0x26d00
    v_add_u32 v61, s14, v61
    v_lshlrev_b32 v62, 2, v1
    v_add_u32 v62, 0x26d00, v62
    s_lshl_b32 s14, s44, 4
    v_lshl_add_u32 v63, v5, 1, s14
    v_add_u32 v20, v7, v63
    ds_read_u16 v21, v20 offset:22784
    s_mov_b32 s94, 0x000f000f
    s_mov_b32 s95, 0x000f000f
    global_load_lds_dwordx4 v44, s[56:57] offset:0
    global_load_lds_dwordx4 v45, s[56:57] offset:1024
    global_load_lds_dwordx4 v46, s[56:57] offset:2048
    global_load_lds_dwordx4 v47, s[56:57] offset:3072
    s_add_u32 s56, s56, 0x4000
    s_addc_u32 s57, s57, 0
    s_add_u32 m0, m0, 0x4000
    s_nop 0
    global_load_lds_dwordx4 v44, s[56:57] offset:0
    global_load_lds_dwordx4 v45, s[56:57] offset:1024
    global_load_lds_dwordx4 v46, s[56:57] offset:2048
    global_load_lds_dwordx4 v47, s[56:57] offset:3072
    s_add_u32 s56, s56, 0x4000
    s_addc_u32 s57, s57, 0
    s_add_u32 m0, m0, 0x4000
    s_waitcnt vmcnt(8)
    s_mov_b64 exec, 1
    ds_add_u32 v7, v12 offset:31276
    s_mov_b64 exec, -1
    s_lshl3_add_u32 s14, s6, s3
    s_add_u32 s14, s14, 96
    s_and_b32 s14, s14, 255
    s_lshl_b32 s14, s14, 6
    s_min_u32 s14, s14, L_code_end-L_pc-4
    s_load_dword s97, s[58:59], s14
    s_lshl_b32 s14, s8, 10
    s_and_b32 s15, s6, 7
    s_lshl_b32 s15, s15, 7
    s_add_u32 s14, s14, s15
    s_lshl_b32 s15, s4, 5
    s_add_u32 s14, s14, s15
    s_add_u32 s14, s14, 0x30000
    s_load_dword s97, s[40:41], s14
    global_load_lds_dwordx4 v44, s[56:57] offset:0
    global_load_lds_dwordx4 v45, s[56:57] offset:1024
    global_load_lds_dwordx4 v46, s[56:57] offset:2048
    global_load_lds_dwordx4 v47, s[56:57] offset:3072
    s_add_u32 s56, s56, 0x4000
    s_addc_u32 s57, s57, 0
    s_add_u32 m0, m0, 0x4000
    s_nop 0
    global_load_lds_dwordx4 v44, s[56:57] offset:0
    global_load_lds_dwordx4 v45, s[56:57] offset:1024
    global_load_lds_dwordx4 v46, s[56:57] offset:2048
    global_load_lds_dwordx4 v47, s[56:57] offset:3072
    s_add_u32 s56, s56, 0x4000
    s_addc_u32 s57, s57, 0
    s_add_u32 m0, m0, 0x4000
    s_mov_b64 exec, 1
    ds_add_u32 v7, v12 offset:31280
    s_mov_b64 exec, -1
    s_setprio 0
    s_bitcmp1_b32 s4, 0
    s_cselect_b64 s[56:57], s[32:33], s[30:31]
    s_waitcnt vmcnt(4)
    global_load_dwordx4 v[64:67], v200, s[56:57]
    s_waitcnt vmcnt(4)
    global_load_dwordx4 v[68:71], v201, s[56:57]
    s_waitcnt vmcnt(4)
    global_load_dwordx4 v[72:75], v202, s[56:57]
    s_waitcnt vmcnt(4)
    global_load_dwordx4 v[76:79], v203, s[56:57]
    s_waitcnt vmcnt(4)
    s_mov_b64 exec, 1
    ds_add_u32 v7, v12 offset:31240
    s_mov_b64 exec, -1
    global_load_dwordx4 v[104:107], v209, s[26:27] offset:-4096
    ds_read_b32 v13, v7 offset:31236
    s_waitcnt lgkmcnt(0)
    v_readfirstlane_b32 s14, v13
    s_nop 0
    s_cmp_ge_u32 s14, 4
    s_cbranch_scc1 L_u5
    s_waitcnt vmcnt(4)
    global_load_dwordx4 v[108:111], v209, s[26:27] offset:0
    ds_read_b32 v13, v7 offset:31236
    s_waitcnt lgkmcnt(0)
    v_readfirstlane_b32 s14, v13
    s_nop 0
    s_cmp_ge_u32 s14, 4
    s_cbranch_scc1 L_u6
    s_waitcnt vmcnt(4)
    global_load_dwordx4 v[112:115], v210, s[26:27] offset:-4096
    ds_read_b32 v13, v7 offset:31236
    s_waitcnt lgkmcnt(0)
    v_readfirstlane_b32 s14, v13
    s_nop 0
    s_cmp_ge_u32 s14, 4
    s_cbranch_scc1 L_u7
    s_waitcnt vmcnt(4)
    global_load_dwordx4 v[116:119], v210, s[26:27] offset:0
    ds_read_b32 v13, v7 offset:31236
    s_waitcnt lgkmcnt(0)
    v_readfirstlane_b32 s14, v13
    s_nop 0
    s_cmp_ge_u32 s14, 4
    s_cbranch_scc1 L_u8
    s_waitcnt vmcnt(4)
    global_load_dwordx4 v[80:83], v217, s[24:25]
    ds_read_b32 v13, v7 offset:31236
    s_waitcnt lgkmcnt(0)
    v_readfirstlane_b32 s14, v13
    s_nop 0
    s_cmp_ge_u32 s14, 4
    s_cbranch_scc1 L_u9
    s_waitcnt vmcnt(4)
    global_load_dwordx4 v[84:87], v218, s[24:25]
    s_branch L_ud
L_u5:
    s_waitcnt vmcnt(6)
    global_load_dwordx4 v[108:111], v209, s[26:27] offset:0
L_u6:
    s_waitcnt vmcnt(6)
    global_load_dwordx4 v[112:115], v210, s[26:27] offset:-4096
L_u7:
    s_waitcnt vmcnt(6)
    global_load_dwordx4 v[116:119], v210, s[26:27] offset:0
L_u8:
    s_waitcnt vmcnt(6)
    global_load_dwordx4 v[80:83], v217, s[24:25]
L_u9:
    s_waitcnt vmcnt(6)
    global_load_dwordx4 v[84:87], v218, s[24:25]
L_ud:
    s_waitcnt vmcnt(6)
    v_mfma_f32_16x16x32_bf16 v[28:31], v[168:171], v[64:67], 0
    v_mfma_f32_16x16x32_bf16 v[28:31], v[172:175], v[68:71], v[28:31]
    v_mfma_f32_16x16x32_bf16 v[28:31], v[176:179], v[72:75], v[28:31]
    v_mfma_f32_16x16x32_bf16 v[28:31], v[180:183], v[76:79], v[28:31]
    s_waitcnt vmcnt(6)
    global_load_dwordx4 v[88:91], v219, s[24:25]
    s_mov_b64 exec, s[92:93]
    s_nop 4
    ds_write_b128 v33, v[28:31] offset:4096
    s_mov_b64 exec, 1
    ds_add_rtn_u32 v13, v7, v12 offset:31260
    s_mov_b64 exec, -1
    ds_read_b128 v[36:39], v34 offset:27904
    ds_read_b128 v[40:43], v34 offset:28160
    ds_read_b128 v[44:47], v34 offset:28416
    ds_read_b128 v[48:51], v34 offset:28672
    s_waitcnt lgkmcnt(0)
    v_readfirstlane_b32 s14, v13
    s_nop 0
    s_cmp_lg_u32 s14, 3
    s_cbranch_scc1 L_nofp
    s_cmp_eq_u32 s96, 0
    s_cbranch_scc1 L_nofp
    v_pk_add_f32 v[36:37], v[36:37], v[40:41]
    v_pk_add_f32 v[38:39], v[38:39], v[42:43]
    v_pk_add_f32 v[44:45], v[44:45], v[48:49]
    v_pk_add_f32 v[46:47], v[46:47], v[50:51]
    v_pk_add_f32 v[36:37], v[36:37], v[44:45]
    v_pk_add_f32 v[38:39], v[38:39], v[46:47]
    v_bfi_b32 v36, v53, s48, v36
    v_bfi_b32 v37, v53, s49, v37
    v_bfi_b32 v38, v53, s50, v38
    v_bfi_b32 v39, v53, s51, v39
    s_mov_b32 exec_lo, 0xffffffff
    s_mov_b32 exec_hi, 0x0
    global_store_dwordx4 v19, v[36:39], s[40:41] sc1
    s_mov_b64 exec, -1
L_nofp:
    s_waitcnt vmcnt(6)
    global_load_dwordx4 v[92:95], v254, s[24:25]
    s_waitcnt vmcnt(6)
    global_load_dwordx4 v[96:99], v255, s[34:35] offset:-4096
    s_waitcnt vmcnt(6)
    global_load_dwordx4 v[100:103], v255, s[34:35] offset:0
    s_lshl3_add_u32 s14, s6, s3
    s_add_u32 s14, s14, 160
    s_and_b32 s14, s14, 255
    s_lshl_b32 s14, s14, 6
    s_min_u32 s14, s14, L_code_end-L_pc-4
    s_load_dword s97, s[58:59], s14
    s_lshl3_add_u32 s14, s6, s3
    s_add_u32 s14, s14, 164
    s_and_b32 s14, s14, 255
    s_lshl_b32 s14, s14, 6
    s_min_u32 s14, s14, L_code_end-L_pc-4
    s_load_dword s97, s[58:59], s14
    v_mul_u32_u24 v14, 37, v2
    v_add_u32 v14, s48, v14
    v_and_b32 v14, 0xff, v14
    v_lshl_or_b32 v14, v14, 15, v14
    v_not_b32 v14, v14
    v_mov_b32 v204, 0x10001
    v_lshrrev_b32 v200, 0, v14
    v_and_b32 v200, v204, v200
    v_lshrrev_b32 v201, 2, v14
    v_and_b32 v201, v204, v201
    v_lshrrev_b32 v202, 4, v14
    v_and_b32 v202, v204, v202
    v_lshrrev_b32 v203, 6, v14
    v_and_b32 v203, v204, v203
    s_lshl2_add_u32 s14, s8, s10
    s_lshl2_add_u32 s14, s14, s4
    s_lshl_b32 s14, s14, 13
    s_add_u32 s14, s14, 0x201000
    v_add_u32 v205, s14, v6
    s_lshl2_add_u32 s14, s8, s4
    s_lshl_b32 s14, s14, 8
    s_add_u32 s14, s14, 0x30000
    v_lshl_add_u32 v206, v3, 3, v5
    v_lshl_add_u32 v206, v206, 3, s14
    s_lshl_b32 s14, s4, 9
    s_add_u32 s14, s14, 0x26500
    v_add_u32 v207, s14, v6
    s_lshl_b32 s14, s4, 2
    v_add_u32 v22, s14, v7
    s_lshl2_add_u32 s14, s7, s4
    s_lshl_b32 s14, s14, 9
    s_add_u32 s14, s14, 0x3000
    v_and_b32 v208, 1, v1
    v_lshl_add_u32 v208, v208, 8, s14
    v_lshl_add_u32 v35, v1, 2, v7
    s_lshl_b32 s14, s4, 10
    s_add_u32 s14, s14, 0x7000
    v_and_b32 v34, 3, v1
    v_lshl_add_u32 v34, v34, 8, s14
    s_bfe_u32 s45, s52, 0xc0010
    s_movk_i32 s44, 64
L_spin_5:
    ds_read_b32 v13, v7 offset:31292
    s_waitcnt lgkmcnt(0)
    v_readfirstlane_b32 s14, v13
    s_nop 0
    s_cmp_ge_u32 s14, 4
    s_cbranch_scc1 L_spind_6
    s_sleep 2
    s_sub_u32 s53, s53, 1
    s_cbranch_scc0 L_spin_5
    s_mov_b32 s53, 0
L_spind_6:
    s_setprio 2
L_f3:
    global_load_dword v23, v208, s[40:41] sc1
    s_waitcnt vmcnt(0)
    v_cmp_ne_u32 vcc, s52, v23
    s_cbranch_vccz L_f3d
    s_sleep 1
    s_sub_u32 s44, s44, 1
    s_cbranch_scc0 L_f3
L_f3d:
    s_branch L_h3
L_st:
    s_sub_u32 s54, s54, 1
    s_cbranch_scc1 L_h3x
    global_load_dwordx2 v[252:253], v206, s[40:41] sc1
    v_bitop3_b32 v14, v220, v221, v222 bitop3:0x80
    v_bitop3_b32 v14, v14, v223, v204 bitop3:0x2a
    v_cmp_ne_u32 vcc, 0, v14
    v_xor_b32 v220, v200, v220
    v_xor_b32 v221, v201, v221
    v_xor_b32 v222, v202, v222
    v_xor_b32 v223, v203, v223
    s_cbranch_vccz L_rs0
    global_load_dwordx4 v[220:223], v205, s[40:41] offset:-4096 sc1
L_rs0:
    v_bitop3_b32 v14, v224, v225, v226 bitop3:0x80
    v_bitop3_b32 v14, v14, v227, v204 bitop3:0x2a
    v_cmp_ne_u32 vcc, 0, v14
    v_xor_b32 v224, v200, v224
    v_xor_b32 v225, v201, v225
    v_xor_b32 v226, v202, v226
    v_xor_b32 v227, v203, v227
    s_cbranch_vccz L_rs1
    global_load_dwordx4 v[224:227], v205, s[40:41] offset:-3072 sc1
L_rs1:
    v_bitop3_b32 v14, v228, v229, v230 bitop3:0x80
    v_bitop3_b32 v14, v14, v231, v204 bitop3:0x2a
    v_cmp_ne_u32 vcc, 0, v14
    v_xor_b32 v228, v200, v228
    v_xor_b32 v229, v201, v229
    v_xor_b32 v230, v202, v230
    v_xor_b32 v231, v203, v231
    s_cbranch_vccz L_rs2
    global_load_dwordx4 v[228:231], v205, s[40:41] offset:-2048 sc1
L_rs2:
    v_bitop3_b32 v14, v232, v233, v234 bitop3:0x80
    v_bitop3_b32 v14, v14, v235, v204 bitop3:0x2a
    v_cmp_ne_u32 vcc, 0, v14
    v_xor_b32 v232, v200, v232
    v_xor_b32 v233, v201, v233
    v_xor_b32 v234, v202, v234
    v_xor_b32 v235, v203, v235
    s_cbranch_vccz L_rs3
    global_load_dwordx4 v[232:235], v205, s[40:41] offset:-1024 sc1
L_rs3:
    v_bitop3_b32 v14, v236, v237, v238 bitop3:0x80
    v_bitop3_b32 v14, v14, v239, v204 bitop3:0x2a
    v_cmp_ne_u32 vcc, 0, v14
    v_xor_b32 v236, v200, v236
    v_xor_b32 v237, v201, v237
    v_xor_b32 v238, v202, v238
    v_xor_b32 v239, v203, v239
    s_cbranch_vccz L_rs4
    global_load_dwordx4 v[236:239], v205, s[40:41] offset:0 sc1
L_rs4:
    v_bitop3_b32 v14, v240, v241, v242 bitop3:0x80
    v_bitop3_b32 v14, v14, v243, v204 bitop3:0x2a
    v_cmp_ne_u32 vcc, 0, v14
    v_xor_b32 v240, v200, v240
    v_xor_b32 v241, v201, v241
    v_xor_b32 v242, v202, v242
    v_xor_b32 v243, v203, v243
    s_cbranch_vccz L_rs5
    global_load_dwordx4 v[240:243], v205, s[40:41] offset:1024 sc1
L_rs5:
    v_bitop3_b32 v14, v244, v245, v246 bitop3:0x80
    v_bitop3_b32 v14, v14, v247, v204 bitop3:0x2a
    v_cmp_ne_u32 vcc, 0, v14
    v_xor_b32 v244, v200, v244
    v_xor_b32 v245, v201, v245
    v_xor_b32 v246, v202, v246
    v_xor_b32 v247, v203, v247
    s_cbranch_vccz L_rs6
    global_load_dwordx4 v[244:247], v205, s[40:41] offset:2048 sc1
L_rs6:
    v_bitop3_b32 v14, v248, v249, v250 bitop3:0x80
    v_bitop3_b32 v14, v14, v251, v204 bitop3:0x2a
    v_cmp_ne_u32 vcc, 0, v14
    v_xor_b32 v248, v200, v248
    v_xor_b32 v249, v201, v249
    v_xor_b32 v250, v202, v250
    v_xor_b32 v251, v203, v251
    s_cbranch_vccz L_rs7
    global_load_dwordx4 v[248:251], v205, s[40:41] offset:3072 sc1
L_rs7:
    s_mov_b32 s42, 1
    s_waitcnt vmcnt(0)
    s_branch L_comp
L_h3:
    global_load_dwordx2 v[252:253], v206, s[40:41] sc1
L_h3b:
    global_load_dwordx4 v[220:223], v205, s[40:41] offset:-4096 sc1
    global_load_dwordx4 v[224:227], v205, s[40:41] offset:-3072 sc1
    global_load_dwordx4 v[228:231], v205, s[40:41] offset:-2048 sc1
    global_load_dwordx4 v[232:235], v205, s[40:41] offset:-1024 sc1
    global_load_dwordx4 v[236:239], v205, s[40:41] offset:0 sc1
    global_load_dwordx4 v[240:243], v205, s[40:41] offset:1024 sc1
    global_load_dwordx4 v[244:247], v205, s[40:41] offset:2048 sc1
    global_load_dwordx4 v[248:251], v205, s[40:41] offset:3072 sc1
    s_mov_b32 s42, 0
    s_waitcnt vmcnt(8)
L_comp:
    v_and_b32 v24, 0xffff0000, v252
    v_mul_f32 v24, 0x3fb8aa3b, v24
    v_xor_b32 v26, s52, v252
    v_mov_b32 v14, v24
    v_xor_b32 v23, s45, v253
    v_and_b32 v26, 0xffff, v26
    v_max_f32_dpp v14, v14, v14 row_ror:4 row_mask:0xf bank_mask:0xf
    v_and_b32 v15, 0xfff, v23
    v_or_b32 v26, v26, v15
    v_max_f32_dpp v14, v14, v14 row_ror:2 row_mask:0xf bank_mask:0xf
    v_mov_b32 v27, -1
    s_nop 0
    v_max_f32_dpp v14, v14, v14 row_ror:1 row_mask:0xf bank_mask:0xf
    v_mov_b32 v15, v14
    s_nop 1
    v_permlane16_swap_b32 v14, v15
    v_max_f32 v14, v14, v15
    v_mov_b32 v15, v14
    s_nop 1
    v_permlane32_swap_b32 v14, v15
    v_max_f32 v14, v14, v15
    v_sub_f32 v24, v24, v14
    v_exp_f32 v24, v24
    s_nop 0
    v_cvt_pk_bf16_f32 v24, v24, v24
    v_and_b32 v25, 0xffff0000, v24
    v_mul_f32 v25, v25, v23
    v_and_b32_dpp v168, v24, v8 row_newbcast:0 row_mask:0xf bank_mask:0xf
    v_and_b32_dpp v169, v24, v9 row_newbcast:0 row_mask:0xf bank_mask:0xf
    v_and_b32_dpp v170, v24, v10 row_newbcast:0 row_mask:0xf bank_mask:0xf
    v_and_b32_dpp v171, v24, v11 row_newbcast:0 row_mask:0xf bank_mask:0xf
    v_add_f32_dpp v25, v25, v25 row_ror:4 row_mask:0xf bank_mask:0xf
    v_and_b32_dpp v172, v24, v8 row_newbcast:1 row_mask:0xf bank_mask:0xf
    v_and_b32_dpp v173, v24, v9 row_newbcast:1 row_mask:0xf bank_mask:0xf
    v_and_b32_dpp v174, v24, v10 row_newbcast:1 row_mask:0xf bank_mask:0xf
    v_and_b32_dpp v175, v24, v11 row_newbcast:1 row_mask:0xf bank_mask:0xf
    v_add_f32_dpp v25, v25, v25 row_ror:2 row_mask:0xf bank_mask:0xf
    v_and_b32_dpp v176, v24, v8 row_newbcast:2 row_mask:0xf bank_mask:0xf
    v_and_b32_dpp v177, v24, v9 row_newbcast:2 row_mask:0xf bank_mask:0xf
    v_and_b32_dpp v178, v24, v10 row_newbcast:2 row_mask:0xf bank_mask:0xf
    v_and_b32_dpp v179, v24, v11 row_newbcast:2 row_mask:0xf bank_mask:0xf
    v_add_f32_dpp v25, v25, v25 row_ror:1 row_mask:0xf bank_mask:0xf
    v_and_b32_dpp v180, v24, v8 row_newbcast:3 row_mask:0xf bank_mask:0xf
    v_and_b32_dpp v181, v24, v9 row_newbcast:3 row_mask:0xf bank_mask:0xf
    v_and_b32_dpp v182, v24, v10 row_newbcast:3 row_mask:0xf bank_mask:0xf
    v_and_b32_dpp v183, v24, v11 row_newbcast:3 row_mask:0xf bank_mask:0xf
    v_mov_b32 v15, v25
    v_and_b32_dpp v64, v24, v8 row_newbcast:4 row_mask:0xf bank_mask:0xf
    v_and_b32_dpp v65, v24, v9 row_newbcast:4 row_mask:0xf bank_mask:0xf
    v_and_b32_dpp v66, v24, v10 row_newbcast:4 row_mask:0xf bank_mask:0xf
    v_and_b32_dpp v67, v24, v11 row_newbcast:4 row_mask:0xf bank_mask:0xf
    v_permlane16_swap_b32 v25, v15
    v_and_b32_dpp v68, v24, v8 row_newbcast:5 row_mask:0xf bank_mask:0xf
    v_and_b32_dpp v69, v24, v9 row_newbcast:5 row_mask:0xf bank_mask:0xf
    v_and_b32_dpp v70, v24, v10 row_newbcast:5 row_mask:0xf bank_mask:0xf
    v_and_b32_dpp v71, v24, v11 row_newbcast:5 row_mask:0xf bank_mask:0xf
    v_add_f32 v25, v25, v15
    v_mov_b32 v15, v25
    v_and_b32_dpp v72, v24, v8 row_newbcast:6 row_mask:0xf bank_mask:0xf
    v_and_b32_dpp v73, v24, v9 row_newbcast:6 row_mask:0xf bank_mask:0xf
    v_and_b32_dpp v74, v24, v10 row_newbcast:6 row_mask:0xf bank_mask:0xf
    v_and_b32_dpp v75, v24, v11 row_newbcast:6 row_mask:0xf bank_mask:0xf
    v_permlane32_swap_b32 v25, v15
    v_and_b32_dpp v76, v24, v8 row_newbcast:7 row_mask:0xf bank_mask:0xf
    v_and_b32_dpp v77, v24, v9 row_newbcast:7 row_mask:0xf bank_mask:0xf
    v_and_b32_dpp v78, v24, v10 row_newbcast:7 row_mask:0xf bank_mask:0xf
    v_and_b32_dpp v79, v24, v11 row_newbcast:7 row_mask:0xf bank_mask:0xf
    v_add_f32 v25, v25, v15
    s_mov_b64 exec, 1
    ds_write_b32 v22, v14 offset:31360
    ds_write_b32 v22, v25 offset:31376
    s_mov_b64 exec, -1
    s_cmp_lg_u32 s42, 0
    s_cbranch_scc1 L_notb
    global_load_dwordx4 v[120:123], v211, s[26:27] offset:-4096
    global_load_dwordx4 v[124:127], v211, s[26:27] offset:0
    global_load_dwordx4 v[128:131], v212, s[26:27] offset:-4096
    global_load_dwordx4 v[132:135], v212, s[26:27] offset:0
    global_load_dwordx4 v[136:139], v213, s[26:27] offset:-4096
    global_load_dwordx4 v[140:143], v213, s[26:27] offset:0
    global_load_dwordx4 v[144:147], v214, s[26:27] offset:-4096
    global_load_dwordx4 v[148:151], v214, s[26:27] offset:0
    global_load_dwordx4 v[152:155], v215, s[26:27] offset:-4096
    global_load_dwordx4 v[156:159], v215, s[26:27] offset:0
    global_load_dwordx4 v[160:163], v216, s[26:27] offset:-4096
    global_load_dwordx4 v[164:167], v216, s[26:27] offset:0
L_notb:
    s_waitcnt vmcnt(19)
    v_xor_b32 v220, v200, v220
    v_xor_b32 v221, v201, v221
    v_xor_b32 v222, v202, v222
    v_xor_b32 v223, v203, v223
    s_waitcnt vmcnt(18)
    v_xor_b32 v224, v200, v224
    v_xor_b32 v225, v201, v225
    v_xor_b32 v226, v202, v226
    v_xor_b32 v227, v203, v227
    v_mfma_f32_16x16x32_bf16 v[28:31], v[168:171], v[220:223], 0
    v_bitop3_b32 v27, v27, v220, v221 bitop3:0x80
    v_bitop3_b32 v27, v27, v222, v223 bitop3:0x80
    s_waitcnt vmcnt(17)
    v_xor_b32 v228, v200, v228
    v_xor_b32 v229, v201, v229
    v_xor_b32 v230, v202, v230
    v_xor_b32 v231, v203, v231
    v_mfma_f32_16x16x32_bf16 v[28:31], v[172:175], v[224:227], v[28:31]
    v_bitop3_b32 v27, v27, v224, v225 bitop3:0x80
    v_bitop3_b32 v27, v27, v226, v227 bitop3:0x80
    s_waitcnt vmcnt(16)
    v_xor_b32 v232, v200, v232
    v_xor_b32 v233, v201, v233
    v_xor_b32 v234, v202, v234
    v_xor_b32 v235, v203, v235
    v_mfma_f32_16x16x32_bf16 v[28:31], v[176:179], v[228:231], v[28:31]
    v_bitop3_b32 v27, v27, v228, v229 bitop3:0x80
    v_bitop3_b32 v27, v27, v230, v231 bitop3:0x80
    s_waitcnt vmcnt(15)
    v_xor_b32 v236, v200, v236
    v_xor_b32 v237, v201, v237
    v_xor_b32 v238, v202, v238
    v_xor_b32 v239, v203, v239
    v_mfma_f32_16x16x32_bf16 v[28:31], v[180:183], v[232:235], v[28:31]
    v_bitop3_b32 v27, v27, v232, v233 bitop3:0x80
    v_bitop3_b32 v27, v27, v234, v235 bitop3:0x80
    s_waitcnt vmcnt(14)
    v_xor_b32 v240, v200, v240
    v_xor_b32 v241, v201, v241
    v_xor_b32 v242, v202, v242
    v_xor_b32 v243, v203, v243
    v_mfma_f32_16x16x32_bf16 v[28:31], v[64:67], v[236:239], v[28:31]
    v_bitop3_b32 v27, v27, v236, v237 bitop3:0x80
    v_bitop3_b32 v27, v27, v238, v239 bitop3:0x80
    s_waitcnt vmcnt(13)
    v_xor_b32 v244, v200, v244
    v_xor_b32 v245, v201, v245
    v_xor_b32 v246, v202, v246
    v_xor_b32 v247, v203, v247
    v_mfma_f32_16x16x32_bf16 v[28:31], v[68:71], v[240:243], v[28:31]
    v_bitop3_b32 v27, v27, v240, v241 bitop3:0x80
    v_bitop3_b32 v27, v27, v242, v243 bitop3:0x80
    s_waitcnt vmcnt(12)
    v_xor_b32 v248, v200, v248
    v_xor_b32 v249, v201, v249
    v_xor_b32 v250, v202, v250
    v_xor_b32 v251, v203, v251
    v_mfma_f32_16x16x32_bf16 v[28:31], v[72:75], v[244:247], v[28:31]
    v_bitop3_b32 v27, v27, v244, v245 bitop3:0x80
    v_bitop3_b32 v27, v27, v246, v247 bitop3:0x80
    v_bitop3_b32 v27, v27, v248, v249 bitop3:0x80
    v_bitop3_b32 v27, v27, v250, v251 bitop3:0x80
    v_mfma_f32_16x16x32_bf16 v[28:31], v[76:79], v[248:251], v[28:31]
    v_bitop3_b32 v27, v27, v204, v26 bitop3:0xae
    v_cmp_ne_u32 vcc, 0, v27
    s_cbranch_vccnz L_st
L_h3x:
    s_mov_b32 exec_hi, 0
    s_nop 3
    ds_write_b128 v207, v[28:31]
    s_mov_b64 exec, 1
    ds_add_u32 v7, v12 offset:31252
    s_mov_b64 exec, -1
L_spin_7:
    ds_read_b32 v13, v7 offset:31252
    ds_read_b128 v[24:27], v7 offset:31360
    ds_read_b128 v[28:31], v7 offset:31376
    ds_read_b128 v[36:39], v54 offset:0
    ds_read_b128 v[40:43], v54 offset:512
    ds_read_b128 v[44:47], v54 offset:1024
    ds_read_b128 v[48:51], v54 offset:1536
    s_waitcnt lgkmcnt(0)
    v_readfirstlane_b32 s14, v13
    s_nop 0
    s_cmp_ge_u32 s14, 4
    s_cbranch_scc1 L_spind_8
    s_sub_u32 s53, s53, 1
    s_cbranch_scc0 L_spin_7
    s_mov_b32 s53, 0
L_spind_8:
    v_max3_f32 v14, v24, v25, v26
    v_max_f32 v14, v14, v27
    v_sub_f32 v24, v24, v14
    v_sub_f32 v25, v25, v14
    v_sub_f32 v26, v26, v14
    v_sub_f32 v27, v27, v14
    v_exp_f32 v24, v24
    v_exp_f32 v25, v25
    v_exp_f32 v26, v26
    v_exp_f32 v27, v27
    v_pk_mul_f32 v[36:37], v[24:25], v[36:37] op_sel_hi:[0,1]
    v_pk_mul_f32 v[38:39], v[24:25], v[38:39] op_sel_hi:[0,1]
    v_pk_fma_f32 v[36:37], v[24:25], v[40:41], v[36:37] op_sel:[1,0,0]
    v_pk_fma_f32 v[38:39], v[24:25], v[42:43], v[38:39] op_sel:[1,0,0]
    v_pk_fma_f32 v[36:37], v[26:27], v[44:45], v[36:37] op_sel_hi:[0,1,1]
    v_pk_fma_f32 v[38:39], v[26:27], v[46:47], v[38:39] op_sel_hi:[0,1,1]
    v_pk_fma_f32 v[36:37], v[26:27], v[48:49], v[36:37] op_sel:[1,0,0]
    v_pk_fma_f32 v[38:39], v[26:27], v[50:51], v[38:39] op_sel:[1,0,0]
    v_cvt_pk_bf16_f32 v40, v36, v36
    v_cvt_pk_bf16_f32 v41, v37, v37
    v_cvt_pk_bf16_f32 v42, v38, v38
    v_cvt_pk_bf16_f32 v43, v39, v39
    s_waitcnt vmcnt(12)
    v_and_b32 v168, v40, v8
    v_and_b32 v169, v40, v9
    v_and_b32 v170, v40, v10
    v_and_b32 v171, v40, v11
    v_and_b32 v172, v41, v8
    v_and_b32 v173, v41, v9
    v_and_b32 v174, v41, v10
    v_and_b32 v175, v41, v11
    v_mfma_f32_16x16x32_bf16 v[44:47], v[168:171], v[80:83], 0
    v_and_b32 v176, v42, v8
    v_and_b32 v177, v42, v9
    v_and_b32 v178, v42, v10
    v_and_b32 v179, v42, v11
    v_mfma_f32_16x16x32_bf16 v[44:47], v[172:175], v[84:87], v[44:47]
    v_and_b32 v180, v43, v8
    v_and_b32 v181, v43, v9
    v_and_b32 v182, v43, v10
    v_and_b32 v183, v43, v11
    v_mfma_f32_16x16x32_bf16 v[44:47], v[176:179], v[88:91], v[44:47]
    v_pk_mul_f32 v[24:25], v[24:25], v[28:29]
    v_mfma_f32_16x16x32_bf16 v[44:47], v[180:183], v[92:95], v[44:47]
    v_pk_fma_f32 v[24:25], v[26:27], v[30:31], v[24:25]
    v_add_f32 v23, v24, v25
    v_rcp_f32 v23, v23
    s_mov_b64 exec, s[92:93]
    s_nop 3
    ds_write_b128 v32, v[44:47]
    s_mov_b64 exec, 1
    ds_add_u32 v7, v12 offset:31256
    s_mov_b64 exec, -1
L_spin_9:
    ds_read_b32 v13, v7 offset:31256
    ds_read_b32 v52, v35 offset:31392
    ds_read2st64_b32 v[36:37], v55 offset0:0 offset1:1
    ds_read2st64_b32 v[38:39], v55 offset0:2 offset1:3
    ds_read2st64_b32 v[40:41], v55 offset0:4 offset1:5
    ds_read2st64_b32 v[42:43], v55 offset0:6 offset1:7
    s_waitcnt lgkmcnt(0)
    v_readfirstlane_b32 s14, v13
    s_nop 0
    s_cmp_ge_u32 s14, 5
    s_cbranch_scc1 L_spind_10
    s_sub_u32 s53, s53, 1
    s_cbranch_scc0 L_spin_9
    s_mov_b32 s53, 0
L_spind_10:
    v_pk_add_f32 v[36:37], v[36:37], v[38:39]
    v_pk_add_f32 v[40:41], v[40:41], v[42:43]
    v_and_b32_dpp v192, v52, v8 row_newbcast:0 row_mask:0xf bank_mask:0xc
    v_and_b32_dpp v193, v52, v9 row_newbcast:0 row_mask:0xf bank_mask:0xc
    v_pk_add_f32 v[36:37], v[36:37], v[40:41]
    v_and_b32_dpp v194, v52, v10 row_newbcast:0 row_mask:0xf bank_mask:0xc
    v_and_b32_dpp v195, v52, v11 row_newbcast:0 row_mask:0xf bank_mask:0xc
    v_add_f32 v24, v36, v37
    v_and_b32_dpp v196, v52, v8 row_newbcast:1 row_mask:0xf bank_mask:0xc
    v_mul_f32 v24, v24, v23
    v_and_b32_dpp v197, v52, v9 row_newbcast:1 row_mask:0xf bank_mask:0xc
    v_cvt_pk_bf16_f32 v24, v24, v24
    v_and_b32_dpp v198, v52, v10 row_newbcast:1 row_mask:0xf bank_mask:0xc
    v_and_b32_dpp v199, v52, v11 row_newbcast:1 row_mask:0xf bank_mask:0xc
    v_mfma_f32_16x16x32_bf16 v[56:59], v[192:195], v[96:99], 0
    v_and_b32_dpp v184, v24, v8 row_newbcast:0 row_mask:0xf bank_mask:0x3
    v_and_b32_dpp v185, v24, v9 row_newbcast:0 row_mask:0xf bank_mask:0x3
    v_and_b32_dpp v186, v24, v10 row_newbcast:0 row_mask:0xf bank_mask:0x3
    v_and_b32_dpp v187, v24, v11 row_newbcast:0 row_mask:0xf bank_mask:0x3
    v_mfma_f32_16x16x32_bf16 v[56:59], v[196:199], v[100:103], v[56:59]
    v_and_b32_dpp v188, v24, v8 row_newbcast:1 row_mask:0xf bank_mask:0x3
    v_and_b32_dpp v189, v24, v9 row_newbcast:1 row_mask:0xf bank_mask:0x3
    v_and_b32_dpp v190, v24, v10 row_newbcast:1 row_mask:0xf bank_mask:0x3
    v_and_b32_dpp v191, v24, v11 row_newbcast:1 row_mask:0xf bank_mask:0x3
    v_mfma_f32_16x16x32_bf16 v[56:59], v[184:187], v[104:107], v[56:59]
    v_and_b32_dpp v184, v24, v8 row_newbcast:2 row_mask:0xf bank_mask:0x3
    v_and_b32_dpp v185, v24, v9 row_newbcast:2 row_mask:0xf bank_mask:0x3
    v_and_b32_dpp v186, v24, v10 row_newbcast:2 row_mask:0xf bank_mask:0x3
    v_and_b32_dpp v187, v24, v11 row_newbcast:2 row_mask:0xf bank_mask:0x3
    v_mfma_f32_16x16x32_bf16 v[56:59], v[188:191], v[108:111], v[56:59]
    v_and_b32_dpp v188, v24, v8 row_newbcast:3 row_mask:0xf bank_mask:0x3
    v_and_b32_dpp v189, v24, v9 row_newbcast:3 row_mask:0xf bank_mask:0x3
    v_and_b32_dpp v190, v24, v10 row_newbcast:3 row_mask:0xf bank_mask:0x3
    v_and_b32_dpp v191, v24, v11 row_newbcast:3 row_mask:0xf bank_mask:0x3
    v_mfma_f32_16x16x32_bf16 v[56:59], v[184:187], v[112:115], v[56:59]
    v_and_b32_dpp v184, v24, v8 row_newbcast:4 row_mask:0xf bank_mask:0x3
    v_and_b32_dpp v185, v24, v9 row_newbcast:4 row_mask:0xf bank_mask:0x3
    v_and_b32_dpp v186, v24, v10 row_newbcast:4 row_mask:0xf bank_mask:0x3
    v_and_b32_dpp v187, v24, v11 row_newbcast:4 row_mask:0xf bank_mask:0x3
    v_mfma_f32_16x16x32_bf16 v[56:59], v[188:191], v[116:119], v[56:59]
    v_and_b32_dpp v188, v24, v8 row_newbcast:5 row_mask:0xf bank_mask:0x3
    v_and_b32_dpp v189, v24, v9 row_newbcast:5 row_mask:0xf bank_mask:0x3
    v_and_b32_dpp v190, v24, v10 row_newbcast:5 row_mask:0xf bank_mask:0x3
    v_and_b32_dpp v191, v24, v11 row_newbcast:5 row_mask:0xf bank_mask:0x3
    s_waitcnt vmcnt(8)
    v_mfma_f32_16x16x32_bf16 v[56:59], v[184:187], v[120:123], v[56:59]
    v_and_b32_dpp v184, v24, v8 row_newbcast:6 row_mask:0xf bank_mask:0x3
    v_and_b32_dpp v185, v24, v9 row_newbcast:6 row_mask:0xf bank_mask:0x3
    v_and_b32_dpp v186, v24, v10 row_newbcast:6 row_mask:0xf bank_mask:0x3
    v_and_b32_dpp v187, v24, v11 row_newbcast:6 row_mask:0xf bank_mask:0x3
    v_mfma_f32_16x16x32_bf16 v[56:59], v[188:191], v[124:127], v[56:59]
    v_and_b32_dpp v188, v24, v8 row_newbcast:7 row_mask:0xf bank_mask:0x3
    v_and_b32_dpp v189, v24, v9 row_newbcast:7 row_mask:0xf bank_mask:0x3
    v_and_b32_dpp v190, v24, v10 row_newbcast:7 row_mask:0xf bank_mask:0x3
    v_and_b32_dpp v191, v24, v11 row_newbcast:7 row_mask:0xf bank_mask:0x3
    v_mfma_f32_16x16x32_bf16 v[56:59], v[184:187], v[128:131], v[56:59]
    v_and_b32_dpp v184, v24, v8 row_newbcast:8 row_mask:0xf bank_mask:0x3
    v_and_b32_dpp v185, v24, v9 row_newbcast:8 row_mask:0xf bank_mask:0x3
    v_and_b32_dpp v186, v24, v10 row_newbcast:8 row_mask:0xf bank_mask:0x3
    v_and_b32_dpp v187, v24, v11 row_newbcast:8 row_mask:0xf bank_mask:0x3
    v_mfma_f32_16x16x32_bf16 v[56:59], v[188:191], v[132:135], v[56:59]
    v_and_b32_dpp v188, v24, v8 row_newbcast:9 row_mask:0xf bank_mask:0x3
    v_and_b32_dpp v189, v24, v9 row_newbcast:9 row_mask:0xf bank_mask:0x3
    v_and_b32_dpp v190, v24, v10 row_newbcast:9 row_mask:0xf bank_mask:0x3
    v_and_b32_dpp v191, v24, v11 row_newbcast:9 row_mask:0xf bank_mask:0x3
    s_waitcnt vmcnt(4)
    v_mfma_f32_16x16x32_bf16 v[56:59], v[184:187], v[136:139], v[56:59]
    v_and_b32_dpp v184, v24, v8 row_newbcast:10 row_mask:0xf bank_mask:0x3
    v_and_b32_dpp v185, v24, v9 row_newbcast:10 row_mask:0xf bank_mask:0x3
    v_and_b32_dpp v186, v24, v10 row_newbcast:10 row_mask:0xf bank_mask:0x3
    v_and_b32_dpp v187, v24, v11 row_newbcast:10 row_mask:0xf bank_mask:0x3
    v_mfma_f32_16x16x32_bf16 v[56:59], v[188:191], v[140:143], v[56:59]
    v_and_b32_dpp v188, v24, v8 row_newbcast:11 row_mask:0xf bank_mask:0x3
    v_and_b32_dpp v189, v24, v9 row_newbcast:11 row_mask:0xf bank_mask:0x3
    v_and_b32_dpp v190, v24, v10 row_newbcast:11 row_mask:0xf bank_mask:0x3
    v_and_b32_dpp v191, v24, v11 row_newbcast:11 row_mask:0xf bank_mask:0x3
    v_mfma_f32_16x16x32_bf16 v[56:59], v[184:187], v[144:147], v[56:59]
    v_and_b32_dpp v184, v24, v8 row_newbcast:12 row_mask:0xf bank_mask:0x3
    v_and_b32_dpp v185, v24, v9 row_newbcast:12 row_mask:0xf bank_mask:0x3
    v_and_b32_dpp v186, v24, v10 row_newbcast:12 row_mask:0xf bank_mask:0x3
    v_and_b32_dpp v187, v24, v11 row_newbcast:12 row_mask:0xf bank_mask:0x3
    v_mfma_f32_16x16x32_bf16 v[56:59], v[188:191], v[148:151], v[56:59]
    v_and_b32_dpp v188, v24, v8 row_newbcast:13 row_mask:0xf bank_mask:0x3
    v_and_b32_dpp v189, v24, v9 row_newbcast:13 row_mask:0xf bank_mask:0x3
    v_and_b32_dpp v190, v24, v10 row_newbcast:13 row_mask:0xf bank_mask:0x3
    v_and_b32_dpp v191, v24, v11 row_newbcast:13 row_mask:0xf bank_mask:0x3
    s_waitcnt vmcnt(0)
    v_mfma_f32_16x16x32_bf16 v[56:59], v[184:187], v[152:155], v[56:59]
    v_and_b32_dpp v184, v24, v8 row_newbcast:14 row_mask:0xf bank_mask:0x3
    v_and_b32_dpp v185, v24, v9 row_newbcast:14 row_mask:0xf bank_mask:0x3
    v_and_b32_dpp v186, v24, v10 row_newbcast:14 row_mask:0xf bank_mask:0x3
    v_and_b32_dpp v187, v24, v11 row_newbcast:14 row_mask:0xf bank_mask:0x3
    v_mfma_f32_16x16x32_bf16 v[56:59], v[188:191], v[156:159], v[56:59]
    v_and_b32_dpp v188, v24, v8 row_newbcast:15 row_mask:0xf bank_mask:0x3
    v_and_b32_dpp v189, v24, v9 row_newbcast:15 row_mask:0xf bank_mask:0x3
    v_and_b32_dpp v190, v24, v10 row_newbcast:15 row_mask:0xf bank_mask:0x3
    v_and_b32_dpp v191, v24, v11 row_newbcast:15 row_mask:0xf bank_mask:0x3
    v_mfma_f32_16x16x32_bf16 v[56:59], v[184:187], v[160:163], v[56:59]
    s_nop 0
    v_mfma_f32_16x16x32_bf16 v[56:59], v[188:191], v[164:167], v[56:59]
    s_nop 7
    v_bfi_b32 v56, v53, s48, v56
    v_bfi_b32 v57, v53, s49, v57
    v_bfi_b32 v58, v53, s50, v58
    v_bfi_b32 v59, v53, s51, v59
    global_store_dwordx4 v18, v[56:59], s[40:41] sc1
    s_cmp_gt_u32 s2, 63
    s_cbranch_scc1 L_sdone
    s_movk_i32 s44, 64
L_f5:
    global_load_dword v15, v34, s[40:41] sc1
    s_waitcnt vmcnt(0)
    v_cmp_ne_u32 vcc, s52, v15
    s_cbranch_vccz L_f5d
    s_sub_u32 s44, s44, 1
    s_cbranch_scc0 L_f5
L_f5d:
    global_load_dwordx4 v[68:71], v60, s[40:41] offset:0 sc1
    global_load_dwordx4 v[72:75], v60, s[40:41] offset:1024 sc1
    global_load_dwordx4 v[76:79], v60, s[40:41] offset:2048 sc1
    global_load_dwordx4 v[80:83], v60, s[40:41] offset:3072 sc1
L_finc:
    s_waitcnt vmcnt(3)
    v_xor_b32 v84, s48, v68
    v_xor_b32 v85, s49, v69
    v_xor_b32 v86, s50, v70
    v_xor_b32 v87, s51, v71
    v_or3_b32 v24, v84, v85, v86
    v_or_b32 v24, v24, v87
    s_waitcnt vmcnt(2)
    v_xor_b32 v88, s48, v72
    v_xor_b32 v89, s49, v73
    v_xor_b32 v90, s50, v74
    v_xor_b32 v91, s51, v75
    v_or3_b32 v25, v88, v89, v90
    v_or_b32 v25, v25, v91
    v_pk_add_f32 v[64:65], v[84:85], v[88:89]
    v_pk_add_f32 v[66:67], v[86:87], v[90:91]
    s_waitcnt vmcnt(1)
    v_xor_b32 v92, s48, v76
    v_xor_b32 v93, s49, v77
    v_xor_b32 v94, s50, v78
    v_xor_b32 v95, s51, v79
    v_or3_b32 v26, v92, v93, v94
    v_or_b32 v26, v26, v95
    v_pk_add_f32 v[64:65], v[64:65], v[92:93]
    v_pk_add_f32 v[66:67], v[66:67], v[94:95]
    s_waitcnt vmcnt(0)
    v_xor_b32 v96, s48, v80
    v_xor_b32 v97, s49, v81
    v_xor_b32 v98, s50, v82
    v_xor_b32 v99, s51, v83
    v_or3_b32 v27, v96, v97, v98
    v_or_b32 v27, v27, v99
    v_pk_add_f32 v[64:65], v[64:65], v[96:97]
    v_pk_add_f32 v[66:67], v[66:67], v[98:99]
    v_or3_b32 v22, v24, v25, v26
    v_or_b32 v22, v22, v27
    v_and_b32 v22, 0xff, v22
    v_cmp_ne_u32 vcc, 0, v22
    s_cbranch_vccz L_find
    s_sub_u32 s54, s54, 1
    s_cbranch_scc1 L_find
    v_and_b32 v24, 0xff, v24
    v_cmp_ne_u32 vcc, 0, v24
    s_cbranch_vccz L_fs0
    s_mov_b64 exec, vcc
    global_load_dwordx4 v[68:71], v60, s[40:41] offset:0 sc1
    s_mov_b64 exec, -1
L_fs0:
    v_and_b32 v25, 0xff, v25
    v_cmp_ne_u32 vcc, 0, v25
    s_cbranch_vccz L_fs1
    s_mov_b64 exec, vcc
    global_load_dwordx4 v[72:75], v60, s[40:41] offset:1024 sc1
    s_mov_b64 exec, -1
L_fs1:
    v_and_b32 v26, 0xff, v26
    v_cmp_ne_u32 vcc, 0, v26
    s_cbranch_vccz L_fs2
    s_mov_b64 exec, vcc
    global_load_dwordx4 v[76:79], v60, s[40:41] offset:2048 sc1
    s_mov_b64 exec, -1
L_fs2:
    v_and_b32 v27, 0xff, v27
    v_cmp_ne_u32 vcc, 0, v27
    s_cbranch_vccz L_fs3
    s_mov_b64 exec, vcc
    global_load_dwordx4 v[80:83], v60, s[40:41] offset:3072 sc1
    s_mov_b64 exec, -1
L_fs3:
    s_waitcnt vmcnt(0)
    s_branch L_finc
L_find:
    v_add_f32_dpp v64, v64, v64 row_ror:4 row_mask:0xf bank_mask:0xf
    v_add_f32_dpp v65, v65, v65 row_ror:4 row_mask:0xf bank_mask:0xf
    v_add_f32_dpp v66, v66, v66 row_ror:4 row_mask:0xf bank_mask:0xf
    v_add_f32_dpp v67, v67, v67 row_ror:4 row_mask:0xf bank_mask:0xf
    v_add_f32_dpp v64, v64, v64 row_ror:8 row_mask:0xf bank_mask:0xf
    v_add_f32_dpp v65, v65, v65 row_ror:8 row_mask:0xf bank_mask:0xf
    v_add_f32_dpp v66, v66, v66 row_ror:8 row_mask:0xf bank_mask:0xf
    v_add_f32_dpp v67, v67, v67 row_ror:8 row_mask:0xf bank_mask:0xf
    s_mov_b64 exec, s[94:95]
    ds_write_b128 v61, v[64:67]
    s_mov_b64 exec, 1
    ds_add_rtn_u32 v13, v7, v12 offset:31264
    s_mov_b64 exec, -1
    ds_read2st64_b32 v[22:23], v62 offset0:0 offset1:1
    ds_read2st64_b32 v[24:25], v62 offset0:2 offset1:3
    s_waitcnt lgkmcnt(0)
    v_readfirstlane_b32 s14, v13
    v_pk_add_f32 v[22:23], v[22:23], v[24:25]
    s_cmp_lg_u32 s14, 3
    s_cbranch_scc1 L_sdone
    v_add_f32 v22, v22, v23
    v_mov_b32 v23, v22
    s_nop 1
    v_permlane16_swap_b32 v22, v23
    v_add_f32 v22, v22, v23
    v_mov_b32 v23, v22
    s_nop 1
    v_permlane32_swap_b32 v22, v23
    v_add_f32 v22, v22, v23
    v_cvt_pk_bf16_f32 v22, v22, v22
    v_and_b32 v22, 0xffff0000, v22
    v_mul_f32 v24, 0xbfb8aa3b, v22
    v_exp_f32 v24, v24
    s_nop 0
    v_add_f32 v24, 1.0, v24
    v_rcp_f32 v24, v24
    s_nop 0
    v_mul_f32 v24, v24, v22
    v_cvt_pk_bf16_f32 v24, v24, v24
    v_and_b32 v24, 0xffff0000, v24
    v_lshlrev_b32 v21, 16, v21
    s_nop 0
    v_mul_f32_dpp v24, v24, v22 row_ror:8 row_mask:0xf bank_mask:0xf
    v_cvt_pk_bf16_f32 v24, v24, v24
    v_and_b32 v24, 0xffff0000, v24
    v_add_f32 v24, v24, v21
    v_cvt_pk_bf16_f32 v24, v24, v24
    s_mov_b64 exec, 0xff
    global_store_short v63, v24, s[36:37]
L_sdone:
    s_endpgm
L_front:
    s_setprio 3
    v_and_b32 v14, 1, v5
    v_lshlrev_b32 v14, 4, v14
    v_mov_b32 v15, 0xffff
    v_lshlrev_b32 v14, v14, v15
    v_lshrrev_b32 v15, 1, v5
    v_cmp_eq_u32 vcc, 0, v15
    v_cmp_eq_u32 s[92:93], 1, v15
    v_cmp_eq_u32 s[94:95], 2, v15
    v_cndmask_b32 v8, 0, v14, vcc
    v_cmp_eq_u32 vcc, 3, v15
    v_cndmask_b32 v9, 0, v14, s[92:93]
    v_cndmask_b32 v10, 0, v14, s[94:95]
    v_cndmask_b32 v11, 0, v14, vcc
    s_mov_b32 s92, 0x00ff00ff
    s_mov_b32 s93, 0xff00ff00
    s_lshl_b32 s14, s4, 9
    s_add_u32 s14, s14, 0x25100
    v_lshl_add_u32 v14, v4, 6, s14
    s_add_u32 s14, s10, 0
    s_and_b32 s14, s14, 3
    s_lshl_b32 s14, s14, 4
    v_add_u32 v56, s14, v14
    s_add_u32 s14, s10, 1
    s_and_b32 s14, s14, 3
    s_lshl_b32 s14, s14, 4
    v_add_u32 v57, s14, v14
    s_add_u32 s14, s10, 2
    s_and_b32 s14, s14, 3
    s_lshl_b32 s14, s14, 4
    v_add_u32 v58, s14, v14
    s_add_u32 s14, s10, 3
    s_and_b32 s14, s14, 3
    s_lshl_b32 s14, s14, 4
    v_add_u32 v59, s14, v14
L_spin_11:
    ds_read_b32 v13, v7 offset:31268
    ds_read_b32 v14, v7 offset:31648
    ds_read_b128 v[144:147], v56
    ds_read_b128 v[148:151], v57
    ds_read_b128 v[152:155], v58
    ds_read_b128 v[156:159], v59
    s_waitcnt lgkmcnt(0)
    v_readfirstlane_b32 s14, v13
    s_nop 0
    s_cmp_ge_u32 s14, 1
    s_cbranch_scc1 L_spind_12
    s_sub_u32 s53, s53, 1
    s_cbranch_scc0 L_spin_11
    s_mov_b32 s53, 0
L_spind_12:
    v_readfirstlane_b32 s52, v14
    s_nop 0
    s_add_u32 s52, s52, 0x01010101
    s_cmp_eq_u32 s52, 0
    s_cselect_b32 s52, 0x01010101, s52
    s_and_b32 s48, s52, 0xff
    s_bfe_u32 s49, s52, 0x80008
    s_bfe_u32 s50, s52, 0x80010
    s_lshr_b32 s51, s52, 24
    v_and_b32 v22, 1, v3
    v_lshlrev_b32 v22, 4, v22
    v_lshl_or_b32 v22, v5, 5, v22
    v_lshrrev_b32 v15, 5, v1
    v_lshl_or_b32 v22, v15, 8, v22
    s_lshl_b32 s14, s4, 9
    s_add_u32 s14, s14, 0x25d00
    v_add_u32 v22, s14, v22
    v_lshrrev_b32 v23, 3, v2
    v_lshl_add_u32 v23, v23, 2, v3
    v_lshl_add_u32 v23, v23, 3, v5
    v_lshlrev_b32 v23, 2, v23
    v_add_u32 v23, 0x25d00, v23
    v_and_b32 v14, 3, v2
    v_xor_b32 v20, v3, v14
    v_lshlrev_b32 v20, 4, v20
    v_lshl_or_b32 v20, v14, 7, v20
    v_lshrrev_b32 v14, 2, v2
    v_lshl_or_b32 v20, v14, 10, v20
    s_lshl_b32 s14, s4, 12
    s_add_u32 s14, s14, 0x20000
    v_add_u32 v20, s14, v20
    v_xor_b32 v21, 64, v20
    s_lshl_b32 s14, s4, 2
    v_add_u32 v14, s14, v3
    v_mul_u32_u24 v14, 37, v14
    v_add_u32 v14, s48, v14
    v_and_b32 v14, 0xff, v14
    v_lshl_or_b32 v208, v14, 15, v14
    v_lshrrev_b32 v209, 2, v208
    v_lshrrev_b32 v210, 4, v208
    v_lshrrev_b32 v211, 6, v208
    v_mov_b32 v26, 0x10001
    s_mov_b32 s45, 0x07060302
    v_and_b32 v160, v144, v8
    v_and_b32 v161, v144, v9
    v_and_b32 v162, v144, v10
    v_and_b32 v163, v144, v11
    v_and_b32 v164, v145, v8
    v_and_b32 v165, v145, v9
    v_and_b32 v166, v145, v10
    v_and_b32 v167, v145, v11
    s_waitcnt vmcnt(19)
    v_mfma_f32_16x16x32_bf16 v[168:171], v[160:163], v[64:67], 0
    v_and_b32 v160, v146, v8
    v_and_b32 v161, v146, v9
    v_and_b32 v162, v146, v10
    v_and_b32 v163, v146, v11
    s_waitcnt vmcnt(18)
    v_mfma_f32_16x16x32_bf16 v[168:171], v[164:167], v[68:71], v[168:171]
    v_and_b32 v164, v147, v8
    v_and_b32 v165, v147, v9
    v_and_b32 v166, v147, v10
    v_and_b32 v167, v147, v11
    s_waitcnt vmcnt(17)
    v_mfma_f32_16x16x32_bf16 v[168:171], v[160:163], v[72:75], v[168:171]
    v_and_b32 v160, v148, v8
    v_and_b32 v161, v148, v9
    v_and_b32 v162, v148, v10
    v_and_b32 v163, v148, v11
    s_waitcnt vmcnt(16)
    v_mfma_f32_16x16x32_bf16 v[168:171], v[164:167], v[76:79], v[168:171]
    v_and_b32 v164, v149, v8
    v_and_b32 v165, v149, v9
    v_and_b32 v166, v149, v10
    v_and_b32 v167, v149, v11
    s_waitcnt vmcnt(11)
    v_mfma_f32_16x16x32_bf16 v[168:171], v[160:163], v[80:83], v[168:171]
    ds_read_b128 v[128:131], v20
    ds_read_b128 v[132:135], v21
    ds_read_b128 v[136:139], v21 offset:512
    ds_read_b128 v[140:143], v20 offset:512
    v_and_b32 v160, v150, v8
    v_and_b32 v161, v150, v9
    v_and_b32 v162, v150, v10
    v_and_b32 v163, v150, v11
    s_waitcnt vmcnt(10)
    v_mfma_f32_16x16x32_bf16 v[168:171], v[164:167], v[84:87], v[168:171]
    v_and_b32 v164, v151, v8
    v_and_b32 v165, v151, v9
    v_and_b32 v166, v151, v10
    v_and_b32 v167, v151, v11
    s_waitcnt vmcnt(9)
    v_mfma_f32_16x16x32_bf16 v[168:171], v[160:163], v[88:91], v[168:171]
    v_and_b32 v160, v152, v8
    v_and_b32 v161, v152, v9
    v_and_b32 v162, v152, v10
    v_and_b32 v163, v152, v11
    s_waitcnt vmcnt(8)
    v_mfma_f32_16x16x32_bf16 v[168:171], v[164:167], v[92:95], v[168:171]
    v_and_b32 v164, v153, v8
    v_and_b32 v165, v153, v9
    v_and_b32 v166, v153, v10
    v_and_b32 v167, v153, v11
    s_waitcnt vmcnt(7)
    v_mfma_f32_16x16x32_bf16 v[168:171], v[160:163], v[96:99], v[168:171]
    v_and_b32 v160, v154, v8
    v_and_b32 v161, v154, v9
    v_and_b32 v162, v154, v10
    v_and_b32 v163, v154, v11
    s_waitcnt vmcnt(6)
    v_mfma_f32_16x16x32_bf16 v[168:171], v[164:167], v[100:103], v[168:171]
    v_and_b32 v164, v155, v8
    v_and_b32 v165, v155, v9
    v_and_b32 v166, v155, v10
    v_and_b32 v167, v155, v11
    s_waitcnt vmcnt(5)
    v_mfma_f32_16x16x32_bf16 v[168:171], v[160:163], v[104:107], v[168:171]
    v_and_b32 v160, v156, v8
    v_and_b32 v161, v156, v9
    v_and_b32 v162, v156, v10
    v_and_b32 v163, v156, v11
    s_waitcnt vmcnt(4)
    v_mfma_f32_16x16x32_bf16 v[168:171], v[164:167], v[108:111], v[168:171]
    v_and_b32 v164, v157, v8
    v_and_b32 v165, v157, v9
    v_and_b32 v166, v157, v10
    v_and_b32 v167, v157, v11
    s_waitcnt vmcnt(3)
    v_mfma_f32_16x16x32_bf16 v[168:171], v[160:163], v[112:115], v[168:171]
    v_and_b32 v160, v158, v8
    v_and_b32 v161, v158, v9
    v_and_b32 v162, v158, v10
    v_and_b32 v163, v158, v11
    s_waitcnt vmcnt(2)
    v_mfma_f32_16x16x32_bf16 v[168:171], v[164:167], v[116:119], v[168:171]
    v_and_b32 v164, v159, v8
    v_and_b32 v165, v159, v9
    v_and_b32 v166, v159, v10
    v_and_b32 v167, v159, v11
    s_waitcnt vmcnt(1)
    v_mfma_f32_16x16x32_bf16 v[168:171], v[160:163], v[120:123], v[168:171]
    s_waitcnt vmcnt(0)
    v_mfma_f32_16x16x32_bf16 v[168:171], v[164:167], v[124:127], v[168:171]
    s_mov_b64 exec, s[92:93]
    s_nop 6
    ds_write_b128 v22, v[168:171]
    s_mov_b64 exec, 1
    ds_add_u32 v7, v12 offset:31232
    s_mov_b64 exec, -1
L_spin_13:
    ds_read_b32 v13, v7 offset:31232
    ds_read2st64_b32 v[172:173], v23 offset0:0 offset1:1
    ds_read2st64_b32 v[174:175], v23 offset0:2 offset1:3
    ds_read2st64_b32 v[176:177], v23 offset0:4 offset1:5
    ds_read2st64_b32 v[178:179], v23 offset0:6 offset1:7
    s_waitcnt lgkmcnt(0)
    v_readfirstlane_b32 s14, v13
    s_nop 0
    s_cmp_ge_u32 s14, 4
    s_cbranch_scc1 L_spind_14
    s_sub_u32 s53, s53, 1
    s_cbranch_scc0 L_spin_13
    s_mov_b32 s53, 0
L_spind_14:
    v_pk_add_f32 v[172:173], v[172:173], v[174:175]
    v_pk_add_f32 v[176:177], v[176:177], v[178:179]
    v_pk_add_f32 v[172:173], v[172:173], v[176:177]
    v_add_f32 v14, v172, v173
    s_nop 1
    v_mov_b32_dpp v15, v14 quad_perm:[1,0,3,2] row_mask:0xf bank_mask:0xf
    v_cvt_pk_bf16_f32 v14, v14, v15
    s_nop 1
    v_mov_b32_dpp v188, v14 row_newbcast:0 row_mask:0xf bank_mask:0xf
    v_mov_b32_dpp v189, v14 row_newbcast:2 row_mask:0xf bank_mask:0xf
    v_mov_b32_dpp v190, v14 row_newbcast:4 row_mask:0xf bank_mask:0xf
    v_mov_b32_dpp v191, v14 row_newbcast:6 row_mask:0xf bank_mask:0xf
    v_mov_b32_dpp v192, v14 row_newbcast:8 row_mask:0xf bank_mask:0xf
    v_mov_b32_dpp v193, v14 row_newbcast:10 row_mask:0xf bank_mask:0xf
    v_mfma_f32_16x16x32_bf16 v[196:199], v[128:131], v[188:191], 0
    v_mov_b32_dpp v194, v14 row_newbcast:12 row_mask:0xf bank_mask:0xf
    v_mov_b32_dpp v195, v14 row_newbcast:14 row_mask:0xf bank_mask:0xf
    v_mfma_f32_16x16x32_bf16 v[200:203], v[136:139], v[188:191], 0
    s_nop 0
    v_mfma_f32_16x16x32_bf16 v[196:199], v[132:135], v[192:195], v[196:199]
    v_mfma_f32_16x16x32_bf16 v[200:203], v[140:143], v[192:195], v[200:203]
    s_mov_b32 exec_lo, 0x10001
    s_mov_b32 exec_hi, 0x10001
    s_nop 4
    v_perm_b32 v196, v197, v196, s45
    v_perm_b32 v197, v199, v198, s45
    v_perm_b32 v198, v201, v200, s45
    v_perm_b32 v199, v203, v202, s45
    v_bfi_b32 v196, v26, v208, v196
    v_bfi_b32 v197, v26, v209, v197
    v_bfi_b32 v198, v26, v210, v198
    v_bfi_b32 v199, v26, v211, v199
    global_store_dwordx4 v25, v[196:199], s[40:41] sc1
    s_mov_b64 exec, -1
    s_lshl2_add_u32 s14, s12, s4
    s_lshl_b32 s14, s14, 13
    s_add_u32 s14, s14, 0x11000
    v_and_b32 v14, 1, v3
    v_lshrrev_b32 v15, 5, v1
    v_lshlrev_b32 v252, 10, v14
    v_lshl_or_b32 v252, v2, 4, v252
    v_lshl_or_b32 v252, v15, 8, v252
    v_add_u32 v252, s14, v252
    v_mul_u32_u24 v253, 1040, v2
    v_lshl_add_u32 v253, v15, 8, v253
    v_lshl_add_u32 v253, v14, 3, v253
    s_lshl_b32 s14, s4, 6
    s_add_u32 s14, s14, 0x20000
    v_add_u32 v253, s14, v253
    v_mul_u32_u24 v14, 37, v2
    v_add_u32 v14, s48, v14
    v_and_b32 v14, 0xff, v14
    v_lshl_or_b32 v29, v14, 15, v14
    v_not_b32 v14, v29
    v_lshrrev_b32 v244, 0, v14
    v_and_b32 v244, 0x10001, v244
    v_lshrrev_b32 v245, 2, v14
    v_and_b32 v245, 0x10001, v245
    v_lshrrev_b32 v246, 4, v14
    v_and_b32 v246, 0x10001, v246
    v_lshrrev_b32 v247, 6, v14
    v_and_b32 v247, 0x10001, v247
    v_mov_b32 v14, 0x3f803f80
    v_cndmask_b32 v14, 0, v14, s[92:93]
    v_and_b32 v248, v14, v8
    v_and_b32 v249, v14, v9
    v_and_b32 v250, v14, v10
    v_and_b32 v251, v14, v11
    v_lshlrev_b32 v14, 1, v5
    v_lshrrev_b32 v15, 3, v2
    v_or_b32 v14, v14, v15
    v_lshlrev_b32 v15, 10, v2
    v_lshl_or_b32 v15, v3, 8, v15
    v_lshl_or_b32 v15, v14, 4, v15
    s_lshl_b32 s14, s4, 14
    v_add_u32 v15, s14, v15
    v_xor_b32 v224, 0, v15
    v_xor_b32 v225, 16, v15
    v_xor_b32 v226, 32, v15
    v_xor_b32 v227, 48, v15
    v_xor_b32 v228, 64, v15
    v_xor_b32 v229, 80, v15
    v_xor_b32 v230, 96, v15
    v_xor_b32 v231, 112, v15
    v_xor_b32 v232, 128, v15
    v_xor_b32 v233, 144, v15
    v_xor_b32 v234, 160, v15
    v_xor_b32 v235, 176, v15
    v_xor_b32 v236, 192, v15
    v_xor_b32 v237, 208, v15
    v_xor_b32 v238, 224, v15
    v_xor_b32 v239, 240, v15
    v_lshrrev_b32 v14, 2, v1
    v_and_b32 v15, 7, v14
    v_lshlrev_b32 v15, 1, v15
    v_lshrrev_b32 v31, 3, v14
    v_or_b32 v15, v15, v31
    v_bfe_u32 v31, v1, 1, 1
    s_lshl_b32 s14, s4, 2
    v_or_b32 v31, s14, v31
    v_xor_b32 v15, v15, v31
    v_lshlrev_b32 v14, 10, v14
    v_lshl_or_b32 v14, v15, 4, v14
    v_and_b32 v24, 1, v1
    v_lshl_or_b32 v24, v24, 3, v14
    v_xor_b32 v25, 32, v24
    v_add_u32 v26, s55, v24
    v_add_u32 v27, s55, v25
    v_add_u32 v31, v7, v6
    v_lshl_add_u32 v255, v2, 2, v7
    s_lshr_b32 s14, s4, 1
    s_lshl_b32 s14, s14, 11
    s_and_b32 s15, s4, 1
    s_lshl3_add_u32 s14, s15, s14
    v_add_u32 v254, s14, v31
    v_mov_b32 v243, 0x3fb8aa3b
    v_mul_u32_u24 v240, 80, v2
    v_add_u32 v240, 0x27500, v240
    v_lshl_add_u32 v241, v3, 2, v240
    s_lshl_b32 s14, s4, 4
    v_add_u32 v241, s14, v241
    s_lshl3_add_u32 s43, s12, s5
    s_lshl_b32 s43, s43, 8
    s_add_u32 s43, s43, 0x1000
    v_mov_b32 v242, s43
    s_and_b32 s14, s11, 0x63
    s_and_b32 s15, s11, 3
    s_mul_i32 s15, s15, 7
    s_add_u32 s14, s14, s15
    s_bfe_u32 s15, s11, 0x30002
    s_add_u32 s14, s14, s15
    s_lshl_b32 s14, s14, 3
    s_lshl_b32 s15, s12, 14
    s_add_u32 s14, s14, s15
    s_add_u32 s14, s14, 0x30000
    v_lshl_add_u32 v28, v2, 10, s14
    s_lshl_b32 s14, s12, 21
    s_lshl_b32 s15, s4, 15
    s_add_u32 s14, s14, s15
    s_lshl_b32 s15, s11, 8
    s_add_u32 s14, s14, s15
    s_add_u32 s14, s14, 0x200000
    v_lshlrev_b32 v30, 19, v3
    v_lshl_or_b32 v30, v2, 4, v30
    v_add_u32 v30, s14, v30
    s_bfe_u32 s45, s52, 0xc0010
    s_mov_b32 s42, 0x10001
    s_mov_b32 s47, 0x07060302
    s_mov_b32 s96, 63
    s_lshl3_add_u32 s14, s6, s3
    s_add_u32 s14, s14, 96
    s_and_b32 s14, s14, 255
    s_lshl_b32 s14, s14, 6
    s_min_u32 s14, s14, L_code_end-L_pc-4
    s_load_dword s97, s[58:59], s14
L_spin_15:
    ds_read_b32 v13, v7 offset:31276
    s_waitcnt lgkmcnt(0)
    v_readfirstlane_b32 s14, v13
    s_nop 0
    s_cmp_ge_u32 s14, 4
    s_cbranch_scc1 L_spind_16
    s_sleep 1
    s_sub_u32 s53, s53, 1
    s_cbranch_scc0 L_spin_15
    s_mov_b32 s53, 0
L_spind_16:
    s_add_u32 s56, s40, 0x20000
    s_addc_u32 s57, s41, 0
    s_add_u32 s58, s40, 0x40000
    s_addc_u32 s59, s41, 0
    s_add_u32 s94, s40, 0x60000
    s_addc_u32 s95, s41, 0
    ds_read_b128 v[96:99], v224
    v_add_u32 v224, s55, v224
    ds_read_b128 v[100:103], v225
    v_add_u32 v225, s55, v225
    ds_read_b128 v[104:107], v226
    v_add_u32 v226, s55, v226
    ds_read_b128 v[108:111], v227
    v_add_u32 v227, s55, v227
    ds_read_b128 v[112:115], v228
    v_add_u32 v228, s55, v228
    ds_read_b128 v[116:119], v229
    v_add_u32 v229, s55, v229
    ds_read_b128 v[120:123], v230
    v_add_u32 v230, s55, v230
    ds_read_b128 v[124:127], v231
    v_add_u32 v231, s55, v231
    ds_read_b128 v[128:131], v232
    v_add_u32 v232, s55, v232
    ds_read_b128 v[132:135], v233
    v_add_u32 v233, s55, v233
    ds_read_b128 v[136:139], v234
    v_add_u32 v234, s55, v234
    ds_read_b128 v[140:143], v235
    v_add_u32 v235, s55, v235
    ds_read_b128 v[144:147], v236
    v_add_u32 v236, s55, v236
    ds_read_b128 v[148:151], v237
    v_add_u32 v237, s55, v237
    ds_read_b128 v[152:155], v238
    v_add_u32 v238, s55, v238
    ds_read_b128 v[156:159], v239
    v_add_u32 v239, s55, v239
L_spin_17:
    ds_read_b32 v13, v7 offset:31280
    s_waitcnt lgkmcnt(0)
    v_readfirstlane_b32 s14, v13
    s_nop 0
    s_cmp_ge_u32 s14, 4
    s_cbranch_scc1 L_spind_18
    s_sleep 1
    s_sub_u32 s53, s53, 1
    s_cbranch_scc0 L_spin_17
    s_mov_b32 s53, 0
L_spind_18:
    s_waitcnt vmcnt(0)
L_h2:
    s_bitcmp0_b32 s96, 0
    s_cbranch_scc1 L_h2i0
    global_load_dwordx4 v[32:35], v252, s[40:41] offset:-4096 sc1
    global_load_dwordx4 v[36:39], v252, s[40:41] offset:-3584 sc1
L_h2i0:
    s_bitcmp0_b32 s96, 1
    s_cbranch_scc1 L_h2i1
    global_load_dwordx4 v[48:51], v252, s[40:41] offset:-2048 sc1
    global_load_dwordx4 v[52:55], v252, s[40:41] offset:-1536 sc1
L_h2i1:
    s_bitcmp0_b32 s96, 2
    s_cbranch_scc1 L_h2i2
    global_load_dwordx4 v[64:67], v252, s[40:41] offset:0 sc1
    global_load_dwordx4 v[68:71], v252, s[40:41] offset:512 sc1
L_h2i2:
    s_bitcmp0_b32 s96, 3
    s_cbranch_scc1 L_h2i3
    global_load_dwordx4 v[80:83], v252, s[40:41] offset:2048 sc1
    global_load_dwordx4 v[84:87], v252, s[40:41] offset:2560 sc1
L_h2i3:
    s_mov_b64 exec, 1
    ds_add_u32 v7, v12 offset:31272
    s_mov_b64 exec, -1
    s_bitcmp1_b32 s96, 4
    s_cbranch_scc1 L_h2f
    s_waitcnt vmcnt(0)
L_h2f:
    s_bitset0_b32 s96, 4
    s_bitcmp0_b32 s96, 5
    s_cbranch_scc1 L_h2w
L_spin_19:
    ds_read_b32 v13, v7 offset:31240
    s_waitcnt lgkmcnt(0)
    v_readfirstlane_b32 s14, v13
    s_nop 0
    s_cmp_ge_u32 s14, 4
    s_cbranch_scc1 L_spind_20
    s_sleep 1
    s_sub_u32 s53, s53, 1
    s_cbranch_scc0 L_spin_19
    s_mov_b32 s53, 0
L_spind_20:
    ds_read_b128 v[160:163], v224
    ds_read_b128 v[164:167], v225
    ds_read_b128 v[168:171], v226
    ds_read_b128 v[172:175], v227
    ds_read_b128 v[176:179], v228
    ds_read_b128 v[180:183], v229
    ds_read_b128 v[184:187], v230
    ds_read_b128 v[188:191], v231
    ds_read_b128 v[192:195], v232
    ds_read_b128 v[196:199], v233
    ds_read_b128 v[200:203], v234
    ds_read_b128 v[204:207], v235
    ds_read_b128 v[208:211], v236
    ds_read_b128 v[212:215], v237
    ds_read_b128 v[216:219], v238
    ds_read_b128 v[220:223], v239
    s_bitset0_b32 s96, 5
L_h2w:
    s_bitcmp0_b32 s96, 0
    s_cbranch_scc1 L_h2p0
    s_waitcnt vmcnt(7)
    v_xor_b32 v32, v244, v32
    v_xor_b32 v33, v245, v33
    v_xor_b32 v34, v246, v34
    v_xor_b32 v35, v247, v35
    s_waitcnt vmcnt(6)
    v_xor_b32 v36, v244, v36
    v_mfma_f32_16x16x32_bf16 v[40:43], v[248:251], v[32:35], 0
    v_xor_b32 v37, v245, v37
    v_xor_b32 v38, v246, v38
    v_xor_b32 v39, v247, v39
    v_bitop3_b32 v14, v32, v33, v34 bitop3:0x80
    v_bitop3_b32 v14, v14, v35, v36 bitop3:0x80
    v_mfma_f32_16x16x32_bf16 v[44:47], v[248:251], v[36:39], 0
    v_bitop3_b32 v14, v14, v37, v38 bitop3:0x80
    v_bitop3_b32 v14, v14, v39, s42 bitop3:0x2a
    v_cmp_ne_u32 vcc, 0, v14
    v_cvt_pk_bf16_f32 v36, v40, v41
    v_cvt_pk_bf16_f32 v37, v42, v43
    s_nop 2
    v_cvt_pk_bf16_f32 v38, v44, v45
    v_cvt_pk_bf16_f32 v39, v46, v47
    ds_write_b64 v253, v[36:37] offset:0
    ds_write_b64 v253, v[38:39] offset:512
    s_cbranch_vccnz L_h2p0
    s_bitset0_b32 s96, 0
L_h2p0:
    s_bitcmp0_b32 s96, 1
    s_cbranch_scc1 L_h2p1
    s_waitcnt vmcnt(5)
    v_xor_b32 v48, v244, v48
    v_xor_b32 v49, v245, v49
    v_xor_b32 v50, v246, v50
    v_xor_b32 v51, v247, v51
    s_waitcnt vmcnt(4)
    v_xor_b32 v52, v244, v52
    v_mfma_f32_16x16x32_bf16 v[56:59], v[248:251], v[48:51], 0
    v_xor_b32 v53, v245, v53
    v_xor_b32 v54, v246, v54
    v_xor_b32 v55, v247, v55
    v_bitop3_b32 v14, v48, v49, v50 bitop3:0x80
    v_bitop3_b32 v14, v14, v51, v52 bitop3:0x80
    v_mfma_f32_16x16x32_bf16 v[60:63], v[248:251], v[52:55], 0
    v_bitop3_b32 v14, v14, v53, v54 bitop3:0x80
    v_bitop3_b32 v14, v14, v55, s42 bitop3:0x2a
    v_cmp_ne_u32 vcc, 0, v14
    v_cvt_pk_bf16_f32 v52, v56, v57
    v_cvt_pk_bf16_f32 v53, v58, v59
    s_nop 2
    v_cvt_pk_bf16_f32 v54, v60, v61
    v_cvt_pk_bf16_f32 v55, v62, v63
    ds_write_b64 v253, v[52:53] offset:16
    ds_write_b64 v253, v[54:55] offset:528
    s_cbranch_vccnz L_h2p1
    s_bitset0_b32 s96, 1
L_h2p1:
    s_bitcmp0_b32 s96, 2
    s_cbranch_scc1 L_h2p2
    s_waitcnt vmcnt(3)
    v_xor_b32 v64, v244, v64
    v_xor_b32 v65, v245, v65
    v_xor_b32 v66, v246, v66
    v_xor_b32 v67, v247, v67
    s_waitcnt vmcnt(2)
    v_xor_b32 v68, v244, v68
    v_mfma_f32_16x16x32_bf16 v[72:75], v[248:251], v[64:67], 0
    v_xor_b32 v69, v245, v69
    v_xor_b32 v70, v246, v70
    v_xor_b32 v71, v247, v71
    v_bitop3_b32 v14, v64, v65, v66 bitop3:0x80
    v_bitop3_b32 v14, v14, v67, v68 bitop3:0x80
    v_mfma_f32_16x16x32_bf16 v[76:79], v[248:251], v[68:71], 0
    v_bitop3_b32 v14, v14, v69, v70 bitop3:0x80
    v_bitop3_b32 v14, v14, v71, s42 bitop3:0x2a
    v_cmp_ne_u32 vcc, 0, v14
    v_cvt_pk_bf16_f32 v68, v72, v73
    v_cvt_pk_bf16_f32 v69, v74, v75
    s_nop 2
    v_cvt_pk_bf16_f32 v70, v76, v77
    v_cvt_pk_bf16_f32 v71, v78, v79
    ds_write_b64 v253, v[68:69] offset:32
    ds_write_b64 v253, v[70:71] offset:544
    s_cbranch_vccnz L_h2p2
    s_bitset0_b32 s96, 2
L_h2p2:
    s_bitcmp0_b32 s96, 3
    s_cbranch_scc1 L_h2p3
    s_waitcnt vmcnt(1)
    v_xor_b32 v80, v244, v80
    v_xor_b32 v81, v245, v81
    v_xor_b32 v82, v246, v82
    v_xor_b32 v83, v247, v83
    s_waitcnt vmcnt(0)
    v_xor_b32 v84, v244, v84
    v_mfma_f32_16x16x32_bf16 v[88:91], v[248:251], v[80:83], 0
    v_xor_b32 v85, v245, v85
    v_xor_b32 v86, v246, v86
    v_xor_b32 v87, v247, v87
    v_bitop3_b32 v14, v80, v81, v82 bitop3:0x80
    v_bitop3_b32 v14, v14, v83, v84 bitop3:0x80
    v_mfma_f32_16x16x32_bf16 v[92:95], v[248:251], v[84:87], 0
    v_bitop3_b32 v14, v14, v85, v86 bitop3:0x80
    v_bitop3_b32 v14, v14, v87, s42 bitop3:0x2a
    v_cmp_ne_u32 vcc, 0, v14
    v_cvt_pk_bf16_f32 v84, v88, v89
    v_cvt_pk_bf16_f32 v85, v90, v91
    s_nop 2
    v_cvt_pk_bf16_f32 v86, v92, v93
    v_cvt_pk_bf16_f32 v87, v94, v95
    ds_write_b64 v253, v[84:85] offset:48
    ds_write_b64 v253, v[86:87] offset:560
    s_cbranch_vccnz L_h2p3
    s_bitset0_b32 s96, 3
L_h2p3:
    s_and_b32 s14, s96, 15
    s_cbranch_scc0 L_h2d
    s_waitcnt lgkmcnt(0)
    s_sleep 2
    s_sub_u32 s54, s54, 1
    s_cbranch_scc0 L_h2
    s_mov_b32 s54, 0
L_h2d:
    s_mov_b64 exec, 1
    ds_add_u32 v7, v12 offset:31236
    s_mov_b64 exec, -1
L_spin_21:
    ds_read_b32 v13, v7 offset:31236
    ds_read_b128 v[32:35], v31 offset:0
    ds_read_b128 v[36:39], v31 offset:1040
    ds_read_b128 v[40:43], v31 offset:2080
    ds_read_b128 v[44:47], v31 offset:3120
    s_waitcnt lgkmcnt(0)
    v_readfirstlane_b32 s14, v13
    s_nop 0
    s_cmp_ge_u32 s14, 4
    s_cbranch_scc1 L_spind_22
    s_sub_u32 s53, s53, 1
    s_cbranch_scc0 L_spin_21
    s_mov_b32 s53, 0
L_spind_22:
    ds_read_b128 v[48:51], v31 offset:4160
    ds_read_b128 v[52:55], v31 offset:5200
    ds_read_b128 v[56:59], v31 offset:6240
    ds_read_b128 v[60:63], v31 offset:7280
    ds_read_b128 v[64:67], v31 offset:8320
    ds_read_b128 v[68:71], v31 offset:9360
    s_cmp_lg_u32 s4, 1
    s_cbranch_scc1 L_noat
    s_mov_b64 exec, 1
    global_atomic_add v0, v242, v12, s[40:41] sc0 sc1
    s_mov_b64 exec, -1
L_noat:
    v_mfma_f32_16x16x32_bf16 v[16:19], v[96:99], v[32:35], 0
    ds_read_b128 v[72:75], v31 offset:10400
    v_mfma_f32_16x16x32_bf16 v[20:23], v[160:163], v[32:35], 0
    ds_read_b128 v[76:79], v31 offset:11440
    v_mfma_f32_16x16x32_bf16 v[16:19], v[100:103], v[36:39], v[16:19]
    ds_read_b128 v[80:83], v31 offset:12480
    v_mfma_f32_16x16x32_bf16 v[20:23], v[164:167], v[36:39], v[20:23]
    ds_read_b128 v[84:87], v31 offset:13520
    v_mfma_f32_16x16x32_bf16 v[16:19], v[104:107], v[40:43], v[16:19]
    ds_read_b128 v[88:91], v31 offset:14560
    v_mfma_f32_16x16x32_bf16 v[20:23], v[168:171], v[40:43], v[20:23]
    ds_read_b128 v[92:95], v31 offset:15600
    v_mfma_f32_16x16x32_bf16 v[16:19], v[108:111], v[44:47], v[16:19]
    v_mfma_f32_16x16x32_bf16 v[20:23], v[172:175], v[44:47], v[20:23]
    s_waitcnt lgkmcnt(11)
    v_mfma_f32_16x16x32_bf16 v[16:19], v[112:115], v[48:51], v[16:19]
    v_mfma_f32_16x16x32_bf16 v[20:23], v[176:179], v[48:51], v[20:23]
    s_waitcnt lgkmcnt(10)
    v_mfma_f32_16x16x32_bf16 v[16:19], v[116:119], v[52:55], v[16:19]
    ds_read_b64_tr_b16 v[96:97], v24 offset:0
    v_mfma_f32_16x16x32_bf16 v[20:23], v[180:183], v[52:55], v[20:23]
    ds_read_b64_tr_b16 v[98:99], v24 offset:16384
    ds_read_b64_tr_b16 v[160:161], v26 offset:0
    s_waitcnt lgkmcnt(12)
    v_mfma_f32_16x16x32_bf16 v[16:19], v[120:123], v[56:59], v[16:19]
    ds_read_b64_tr_b16 v[162:163], v26 offset:16384
    v_mfma_f32_16x16x32_bf16 v[20:23], v[184:187], v[56:59], v[20:23]
    ds_read_b64_tr_b16 v[100:101], v25 offset:0
    ds_read_b64_tr_b16 v[102:103], v25 offset:16384
    s_waitcnt lgkmcnt(14)
    v_mfma_f32_16x16x32_bf16 v[16:19], v[124:127], v[60:63], v[16:19]
    ds_read_b64_tr_b16 v[164:165], v27 offset:0
    v_mfma_f32_16x16x32_bf16 v[20:23], v[188:191], v[60:63], v[20:23]
    ds_read_b64_tr_b16 v[166:167], v27 offset:16384
    ds_read_b64_tr_b16 v[104:105], v24 offset:256
    s_waitcnt lgkmcnt(14)
    v_mfma_f32_16x16x32_bf16 v[16:19], v[128:131], v[64:67], v[16:19]
    ds_read_b64_tr_b16 v[106:107], v24 offset:16640
    v_mfma_f32_16x16x32_bf16 v[20:23], v[192:195], v[64:67], v[20:23]
    ds_read_b64_tr_b16 v[168:169], v26 offset:256
    ds_read_b64_tr_b16 v[170:171], v26 offset:16640
    s_waitcnt lgkmcnt(14)
    v_mfma_f32_16x16x32_bf16 v[16:19], v[132:135], v[68:71], v[16:19]
    ds_read_b64_tr_b16 v[108:109], v25 offset:256
    v_mfma_f32_16x16x32_bf16 v[20:23], v[196:199], v[68:71], v[20:23]
    ds_read_b64_tr_b16 v[110:111], v25 offset:16640
    ds_read_b64_tr_b16 v[172:173], v27 offset:256
    s_waitcnt lgkmcnt(14)
    v_mfma_f32_16x16x32_bf16 v[16:19], v[136:139], v[72:75], v[16:19]
    ds_read_b64_tr_b16 v[174:175], v27 offset:16640
    v_mfma_f32_16x16x32_bf16 v[20:23], v[200:203], v[72:75], v[20:23]
    ds_read_b64_tr_b16 v[112:113], v24 offset:512
    ds_read_b64_tr_b16 v[114:115], v24 offset:16896
    s_waitcnt lgkmcnt(14)
    v_mfma_f32_16x16x32_bf16 v[16:19], v[140:143], v[76:79], v[16:19]
    ds_read_b64_tr_b16 v[176:177], v26 offset:512
    v_mfma_f32_16x16x32_bf16 v[20:23], v[204:207], v[76:79], v[20:23]
    ds_read_b64_tr_b16 v[178:179], v26 offset:16896
    ds_read_b64_tr_b16 v[116:117], v25 offset:512
    s_waitcnt lgkmcnt(14)
    v_mfma_f32_16x16x32_bf16 v[16:19], v[144:147], v[80:83], v[16:19]
    ds_read_b64_tr_b16 v[118:119], v25 offset:16896
    v_mfma_f32_16x16x32_bf16 v[20:23], v[208:211], v[80:83], v[20:23]
    ds_read_b64_tr_b16 v[180:181], v27 offset:512
    ds_read_b64_tr_b16 v[182:183], v27 offset:16896
    s_waitcnt lgkmcnt(14)
    v_mfma_f32_16x16x32_bf16 v[16:19], v[148:151], v[84:87], v[16:19]
    ds_read_b64_tr_b16 v[120:121], v24 offset:768
    v_mfma_f32_16x16x32_bf16 v[20:23], v[212:215], v[84:87], v[20:23]
    ds_read_b64_tr_b16 v[122:123], v24 offset:17152
    ds_read_b64_tr_b16 v[184:185], v26 offset:768
    s_waitcnt lgkmcnt(14)
    v_mfma_f32_16x16x32_bf16 v[16:19], v[152:155], v[88:91], v[16:19]
    ds_read_b64_tr_b16 v[186:187], v26 offset:17152
    v_mfma_f32_16x16x32_bf16 v[20:23], v[216:219], v[88:91], v[20:23]
    ds_read_b64_tr_b16 v[124:125], v25 offset:768
    ds_read_b64_tr_b16 v[126:127], v25 offset:17152
    s_waitcnt lgkmcnt(14)
    v_mfma_f32_16x16x32_bf16 v[16:19], v[156:159], v[92:95], v[16:19]
    ds_read_b64_tr_b16 v[188:189], v27 offset:768
    v_mfma_f32_16x16x32_bf16 v[20:23], v[220:223], v[92:95], v[20:23]
    ds_read_b64_tr_b16 v[190:191], v27 offset:17152
    s_nop 4
    v_max3_f32 v14, v16, v17, v18
    v_max_f32 v14, v14, v19
    v_max3_f32 v14, v14, v20, v21
    v_max3_f32 v14, v14, v22, v23
    ds_max_f32 v255, v14 offset:31296
    s_mov_b64 exec, 1
    ds_add_u32 v7, v12 offset:31244
    s_mov_b64 exec, -1
    ds_read_b32 v13, v7 offset:31244
    ds_read_b32 v52, v255 offset:31296
    ds_read_b64_tr_b16 v[128:129], v24 offset:32768
    ds_read_b64_tr_b16 v[130:131], v24 offset:49152
    ds_read_b64_tr_b16 v[192:193], v26 offset:32768
    ds_read_b64_tr_b16 v[194:195], v26 offset:49152
    v_cvt_pk_bf16_f32 v17, v16, v17
    v_cvt_pk_bf16_f32 v19, v18, v19
    v_cvt_pk_bf16_f32 v21, v20, v21
    v_cvt_pk_bf16_f32 v23, v22, v23
    v_lshlrev_b32 v16, 16, v17
    v_and_b32 v17, 0xffff0000, v17
    v_lshlrev_b32 v18, 16, v19
    v_and_b32 v19, 0xffff0000, v19
    v_lshlrev_b32 v20, 16, v21
    v_and_b32 v21, 0xffff0000, v21
    v_lshlrev_b32 v22, 16, v23
    v_and_b32 v23, 0xffff0000, v23
    v_mul_f32 v16, 0x3db504f3, v16
    v_mul_f32 v17, 0x3db504f3, v17
    v_mul_f32 v18, 0x3db504f3, v18
    v_mul_f32 v19, 0x3db504f3, v19
    v_mul_f32 v20, 0x3db504f3, v20
    v_mul_f32 v21, 0x3db504f3, v21
    v_mul_f32 v22, 0x3db504f3, v22
    v_mul_f32 v23, 0x3db504f3, v23
    v_cvt_pk_bf16_f32 v17, v16, v17
    v_cvt_pk_bf16_f32 v19, v18, v19
    v_cvt_pk_bf16_f32 v21, v20, v21
    v_cvt_pk_bf16_f32 v23, v22, v23
    v_lshlrev_b32 v16, 16, v17
    v_and_b32 v17, 0xffff0000, v17
    v_lshlrev_b32 v18, 16, v19
    v_and_b32 v19, 0xffff0000, v19
    v_lshlrev_b32 v20, 16, v21
    v_and_b32 v21, 0xffff0000, v21
    v_lshlrev_b32 v22, 16, v23
    v_and_b32 v23, 0xffff0000, v23
    s_waitcnt lgkmcnt(4)
    v_readfirstlane_b32 s14, v13
    s_nop 0
    s_cmp_ge_u32 s14, 4
    s_cbranch_scc1 L_sw_23
L_spin_24:
    ds_read_b32 v13, v7 offset:31244
    ds_read_b32 v52, v255 offset:31296
    s_waitcnt lgkmcnt(0)
    v_readfirstlane_b32 s14, v13
    s_nop 0
    s_cmp_ge_u32 s14, 4
    s_cbranch_scc1 L_spind_25
    s_sub_u32 s53, s53, 1
    s_cbranch_scc0 L_spin_24
    s_mov_b32 s53, 0
L_spind_25:
L_sw_23:
    v_cvt_pk_bf16_f32 v52, v52, v52
    v_and_b32 v52, 0xffff0000, v52
    ds_read_b64_tr_b16 v[132:133], v25 offset:32768
    v_mul_f32 v52, 0x3db504f3, v52
    ds_read_b64_tr_b16 v[134:135], v25 offset:49152
    v_cvt_pk_bf16_f32 v52, v52, v52
    v_and_b32 v52, 0xffff0000, v52
    ds_read_b64_tr_b16 v[196:197], v27 offset:32768
    v_mul_f32 v14, 0xbfb8aa3b, v52
    ds_read_b64_tr_b16 v[198:199], v27 offset:49152
    v_fma_f32 v16, v16, v243, v14
    v_fma_f32 v17, v17, v243, v14
    v_fma_f32 v18, v18, v243, v14
    v_fma_f32 v19, v19, v243, v14
    v_fma_f32 v20, v20, v243, v14
    v_fma_f32 v21, v21, v243, v14
    v_fma_f32 v22, v22, v243, v14
    v_fma_f32 v23, v23, v243, v14
    v_exp_f32 v16, v16
    ds_read_b64_tr_b16 v[136:137], v24 offset:33024
    v_exp_f32 v17, v17
    ds_read_b64_tr_b16 v[138:139], v24 offset:49408
    v_exp_f32 v18, v18
    ds_read_b64_tr_b16 v[200:201], v26 offset:33024
    v_exp_f32 v19, v19
    ds_read_b64_tr_b16 v[202:203], v26 offset:49408
    v_cvt_pk_bf16_f32 v48, v16, v17
    v_exp_f32 v20, v20
    ds_read_b64_tr_b16 v[140:141], v25 offset:33024
    v_exp_f32 v21, v21
    ds_read_b64_tr_b16 v[142:143], v25 offset:49408
    v_cvt_pk_bf16_f32 v49, v18, v19
    v_exp_f32 v22, v22
    ds_read_b64_tr_b16 v[204:205], v27 offset:33024
    v_exp_f32 v23, v23
    ds_read_b64_tr_b16 v[206:207], v27 offset:49408
    v_cvt_pk_bf16_f32 v50, v20, v21
    ds_write_b64 v254, v[48:49] offset:16640
    v_cvt_pk_bf16_f32 v51, v22, v23
    ds_write_b64 v254, v[50:51] offset:17664
    s_mov_b64 exec, 1
    ds_add_u32 v7, v12 offset:31248
    s_mov_b64 exec, -1
    v_add_f32 v16, v16, v17
    v_add_f32 v18, v18, v19
    v_add_f32 v20, v20, v21
    v_add_f32 v22, v22, v23
    ds_read_b32 v13, v7 offset:31248
    ds_read_b128 v[32:35], v31 offset:16640
    ds_read_b128 v[36:39], v31 offset:17664
    ds_read_b128 v[40:43], v31 offset:18688
    ds_read_b128 v[44:47], v31 offset:19712
    v_add_f32 v16, v16, v18
    v_add_f32 v20, v20, v22
    v_add_f32 v14, v16, v20
    v_mov_b32 v54, v240
    ds_write_b32 v241, v14
    s_mov_b64 exec, 1
    ds_add_u32 v7, v12 offset:31288
    s_mov_b64 exec, -1
    v_lshrrev_b32 v56, 0, v29
    v_lshrrev_b32 v57, 2, v29
    v_lshrrev_b32 v58, 4, v29
    v_lshrrev_b32 v59, 6, v29
    v_mov_b32 v60, 0x10001
    s_waitcnt lgkmcnt(2)
    v_readfirstlane_b32 s14, v13
    s_nop 0
    s_cmp_ge_u32 s14, 4
    s_cbranch_scc1 L_sw_26
L_spin_27:
    ds_read_b32 v13, v7 offset:31248
    ds_read_b128 v[32:35], v31 offset:16640
    ds_read_b128 v[36:39], v31 offset:17664
    ds_read_b128 v[40:43], v31 offset:18688
    ds_read_b128 v[44:47], v31 offset:19712
    s_waitcnt lgkmcnt(0)
    v_readfirstlane_b32 s14, v13
    s_nop 0
    s_cmp_ge_u32 s14, 4
    s_cbranch_scc1 L_spind_28
    s_sub_u32 s53, s53, 1
    s_cbranch_scc0 L_spin_27
    s_mov_b32 s53, 0
L_spind_28:
L_sw_26:
    v_mfma_f32_16x16x32_bf16 v[224:227], v[32:35], v[96:99], 0
    ds_read_b64_tr_b16 v[144:145], v24 offset:33280
    v_mfma_f32_16x16x32_bf16 v[228:231], v[32:35], v[100:103], 0
    ds_read_b64_tr_b16 v[146:147], v24 offset:49664
    v_mfma_f32_16x16x32_bf16 v[224:227], v[36:39], v[160:163], v[224:227]
    ds_read_b64_tr_b16 v[208:209], v26 offset:33280
    v_mfma_f32_16x16x32_bf16 v[228:231], v[36:39], v[164:167], v[228:231]
    ds_read_b64_tr_b16 v[210:211], v26 offset:49664
    v_mfma_f32_16x16x32_bf16 v[224:227], v[40:43], v[128:131], v[224:227]
    ds_read_b64_tr_b16 v[148:149], v25 offset:33280
    v_mfma_f32_16x16x32_bf16 v[228:231], v[40:43], v[132:135], v[228:231]
    ds_read_b64_tr_b16 v[150:151], v25 offset:49664
    v_mfma_f32_16x16x32_bf16 v[224:227], v[44:47], v[192:195], v[224:227]
    ds_read_b64_tr_b16 v[212:213], v27 offset:33280
    v_mfma_f32_16x16x32_bf16 v[228:231], v[44:47], v[196:199], v[228:231]
    ds_read_b64_tr_b16 v[214:215], v27 offset:49664
    v_mfma_f32_16x16x32_bf16 v[232:235], v[32:35], v[104:107], 0
    ds_read_b64_tr_b16 v[152:153], v24 offset:33536
    ds_read_b64_tr_b16 v[154:155], v24 offset:49920
    v_mfma_f32_16x16x32_bf16 v[236:239], v[32:35], v[108:111], 0
    ds_read_b64_tr_b16 v[216:217], v26 offset:33536
    ds_read_b64_tr_b16 v[218:219], v26 offset:49920
    v_mfma_f32_16x16x32_bf16 v[232:235], v[36:39], v[168:171], v[232:235]
    ds_read_b64_tr_b16 v[156:157], v25 offset:33536
    ds_read_b64_tr_b16 v[158:159], v25 offset:49920
    v_mfma_f32_16x16x32_bf16 v[236:239], v[36:39], v[172:175], v[236:239]
    ds_read_b64_tr_b16 v[220:221], v27 offset:33536
    ds_read_b64_tr_b16 v[222:223], v27 offset:49920
    v_mfma_f32_16x16x32_bf16 v[232:235], v[40:43], v[136:139], v[232:235]
    v_perm_b32 v80, v228, v224, s47
    v_perm_b32 v84, v229, v225, s47
    v_mfma_f32_16x16x32_bf16 v[236:239], v[40:43], v[140:143], v[236:239]
    v_perm_b32 v88, v230, v226, s47
    v_perm_b32 v92, v231, v227, s47
    v_mfma_f32_16x16x32_bf16 v[232:235], v[44:47], v[200:203], v[232:235]
    v_bfi_b32 v80, v60, v56, v80
    v_bfi_b32 v84, v60, v56, v84
    v_mfma_f32_16x16x32_bf16 v[236:239], v[44:47], v[204:207], v[236:239]
    v_bfi_b32 v88, v60, v56, v88
    v_bfi_b32 v92, v60, v56, v92
    s_cmp_lg_u32 s4, 1
    s_cbranch_scc1 L_nolast
    s_waitcnt vmcnt(0)
    v_readfirstlane_b32 s44, v0
    s_nop 0
    s_sub_u32 s44, s44, s52
    s_cmp_lg_u32 s44, 15
    s_cbranch_scc1 L_nolast
    s_add_u32 s43, s43, 0x2000
    v_mov_b32 v61, s43
    v_mov_b32 v62, s52
    s_mov_b64 exec, 1
    global_store_dword v61, v62, s[40:41] sc1
    s_mov_b64 exec, -1
L_nolast:
    v_mfma_f32_16x16x32_bf16 v[240:243], v[32:35], v[112:115], 0
    v_mfma_f32_16x16x32_bf16 v[244:247], v[32:35], v[116:119], 0
    v_mfma_f32_16x16x32_bf16 v[240:243], v[36:39], v[176:179], v[240:243]
    v_mfma_f32_16x16x32_bf16 v[244:247], v[36:39], v[180:183], v[244:247]
    s_waitcnt lgkmcnt(8)
    v_mfma_f32_16x16x32_bf16 v[240:243], v[40:43], v[144:147], v[240:243]
    v_perm_b32 v81, v236, v232, s47
    v_perm_b32 v85, v237, v233, s47
    v_mfma_f32_16x16x32_bf16 v[244:247], v[40:43], v[148:151], v[244:247]
    v_perm_b32 v89, v238, v234, s47
    v_perm_b32 v93, v239, v235, s47
    v_mfma_f32_16x16x32_bf16 v[240:243], v[44:47], v[208:211], v[240:243]
    v_bfi_b32 v81, v60, v57, v81
    v_bfi_b32 v85, v60, v57, v85
    v_mfma_f32_16x16x32_bf16 v[244:247], v[44:47], v[212:215], v[244:247]
    v_bfi_b32 v89, v60, v57, v89
    v_bfi_b32 v93, v60, v57, v93
    v_mfma_f32_16x16x32_bf16 v[248:251], v[32:35], v[120:123], 0
    v_mfma_f32_16x16x32_bf16 v[252:255], v[32:35], v[124:127], 0
    v_mfma_f32_16x16x32_bf16 v[248:251], v[36:39], v[184:187], v[248:251]
    v_mfma_f32_16x16x32_bf16 v[252:255], v[36:39], v[188:191], v[252:255]
    s_waitcnt lgkmcnt(0)
    v_mfma_f32_16x16x32_bf16 v[248:251], v[40:43], v[152:155], v[248:251]
    v_perm_b32 v82, v244, v240, s47
    v_perm_b32 v86, v245, v241, s47
    v_mfma_f32_16x16x32_bf16 v[252:255], v[40:43], v[156:159], v[252:255]
    v_perm_b32 v90, v246, v242, s47
    v_perm_b32 v94, v247, v243, s47
    v_mfma_f32_16x16x32_bf16 v[248:251], v[44:47], v[216:219], v[248:251]
    v_bfi_b32 v82, v60, v58, v82
    v_bfi_b32 v86, v60, v58, v86
    v_mfma_f32_16x16x32_bf16 v[252:255], v[44:47], v[220:223], v[252:255]
    v_bfi_b32 v90, v60, v58, v90
    v_bfi_b32 v94, v60, v58, v94
    s_nop 5
    v_perm_b32 v83, v252, v248, s47
    v_perm_b32 v87, v253, v249, s47
    v_perm_b32 v91, v254, v250, s47
    v_perm_b32 v95, v255, v251, s47
    v_bfi_b32 v83, v60, v59, v83
    global_store_dwordx4 v30, v[80:83], s[40:41] sc1
    v_bfi_b32 v87, v60, v59, v87
    global_store_dwordx4 v30, v[84:87], s[56:57] sc1
    v_bfi_b32 v91, v60, v59, v91
    global_store_dwordx4 v30, v[88:91], s[58:59] sc1
    v_bfi_b32 v95, v60, v59, v95
    global_store_dwordx4 v30, v[92:95], s[94:95] sc1
    s_cmp_lg_u32 s4, 0
    s_cbranch_scc1 L_nostat
    v_mov_b32 v14, 0xffff
    v_bfi_b32 v52, v14, s52, v52
    v_mov_b32 v15, 0xfff
L_spin_29:
    ds_read_b32 v13, v7 offset:31288
    ds_read_b128 v[64:67], v54 offset:0
    ds_read_b128 v[68:71], v54 offset:16
    ds_read_b128 v[72:75], v54 offset:32
    ds_read_b128 v[76:79], v54 offset:48
    s_waitcnt lgkmcnt(0)
    v_readfirstlane_b32 s14, v13
    s_nop 0
    s_cmp_ge_u32 s14, 4
    s_cbranch_scc1 L_spind_30
    s_sub_u32 s53, s53, 1
    s_cbranch_scc0 L_spin_29
    s_mov_b32 s53, 0
L_spind_30:
    v_pk_add_f32 v[64:65], v[64:65], v[72:73]
    v_pk_add_f32 v[66:67], v[66:67], v[74:75]
    v_pk_add_f32 v[68:69], v[68:69], v[76:77]
    v_pk_add_f32 v[70:71], v[70:71], v[78:79]
    v_pk_add_f32 v[64:65], v[64:65], v[66:67]
    v_pk_add_f32 v[68:69], v[68:69], v[70:71]
    v_pk_add_f32 v[64:65], v[64:65], v[68:69]
    v_add_f32 v53, v64, v65
    v_bfi_b32 v53, v15, s45, v53
    s_mov_b64 exec, 0xffff
    global_store_dwordx2 v28, v[52:53], s[40:41] sc1
    s_mov_b64 exec, -1
L_nostat:
    s_setprio 0
    s_waitcnt vmcnt(0)
    s_mov_b64 exec, 1
    ds_add_u32 v7, v12 offset:31292
    s_mov_b64 exec, -1
    s_cmp_lg_u32 s4, 2
    s_cbranch_scc1 L_nofh
    s_lshr_b32 s14, s5, 1
    s_lshl2_add_u32 s14, s7, s14
    s_mul_i32 s43, s14, 28
    s_and_b32 s14, s5, 1
    s_mul_i32 s15, s14, 12
    s_add_u32 s43, s43, s15
    s_add_u32 s43, s43, s13
    s_lshl2_add_u32 s14, s14, 12
    v_mov_b32 v52, 0
    v_lshl_add_u32 v35, v1, 2, v7
    s_cmp_ge_u32 s13, s14
    s_cbranch_scc1 L_nof2
    s_lshl_b32 s14, s43, 9
    s_add_u32 s14, s14, 0x38000
    v_and_b32 v14, 0x1f0, v6
    v_add_u32 v14, s14, v14
L_spin_31:
    ds_read_b32 v13, v7 offset:31292
    s_waitcnt lgkmcnt(0)
    v_readfirstlane_b32 s14, v13
    s_nop 0
    s_cmp_ge_u32 s14, 4
    s_cbranch_scc1 L_spind_32
    s_sleep 2
    s_sub_u32 s53, s53, 1
    s_cbranch_scc0 L_spin_31
    s_mov_b32 s53, 0
L_spind_32:
L_fhop_33:
    global_load_dwordx4 v[36:39], v14, s[40:41] sc1
    s_waitcnt vmcnt(0)
    v_xor_b32 v36, s48, v36
    v_xor_b32 v37, s49, v37
    v_xor_b32 v38, s50, v38
    v_xor_b32 v39, s51, v39
    v_or3_b32 v15, v36, v37, v38
    v_or_b32 v15, v15, v39
    v_and_b32 v15, 0xff, v15
    v_cmp_ne_u32 vcc, 0, v15
    s_cbranch_vccz L_fhopd_34
    s_sleep 6
    s_sub_u32 s54, s54, 1
    s_cbranch_scc0 L_fhop_33
    s_mov_b32 s54, 0
L_fhopd_34:
    v_add_f32_dpp v36, v36, v36 row_ror:4 row_mask:0xf bank_mask:0xf
    v_add_f32_dpp v37, v37, v37 row_ror:4 row_mask:0xf bank_mask:0xf
    v_add_f32_dpp v38, v38, v38 row_ror:4 row_mask:0xf bank_mask:0xf
    v_add_f32_dpp v39, v39, v39 row_ror:4 row_mask:0xf bank_mask:0xf
    v_add_f32_dpp v36, v36, v36 row_ror:8 row_mask:0xf bank_mask:0xf
    v_add_f32_dpp v37, v37, v37 row_ror:8 row_mask:0xf bank_mask:0xf
    v_add_f32_dpp v38, v38, v38 row_ror:8 row_mask:0xf bank_mask:0xf
    v_add_f32_dpp v39, v39, v39 row_ror:8 row_mask:0xf bank_mask:0xf
    v_mov_b32 v40, v36
    v_mov_b32 v41, v37
    v_mov_b32 v42, v38
    v_mov_b32 v43, v39
    v_permlane16_swap_b32 v36, v40
    v_permlane16_swap_b32 v37, v41
    v_permlane16_swap_b32 v38, v42
    v_permlane16_swap_b32 v39, v43
    v_add_f32 v36, v36, v40
    v_add_f32 v37, v37, v41
    v_add_f32 v38, v38, v42
    v_add_f32 v39, v39, v43
    v_mov_b32_dpp v36, v37 quad_perm:[0,1,2,3] row_mask:0x2 bank_mask:0xf
    v_mov_b32_dpp v36, v38 quad_perm:[0,1,2,3] row_mask:0x4 bank_mask:0xf
    v_mov_b32_dpp v36, v39 quad_perm:[0,1,2,3] row_mask:0x8 bank_mask:0xf
    v_cvt_pk_bf16_f32 v36, v36, v36
    v_and_b32 v36, 0xffff0000, v36
    s_nop 1
    v_mov_b32_dpp v37, v36 quad_perm:[2,3,2,3] row_mask:0xf bank_mask:0xf
    v_mul_f32 v38, v36, v36
    v_mov_b32 v39, 0x3d372713
    v_fma_f32 v38, v38, v39, 1.0
    v_mul_f32 v38, v38, v36
    v_mul_f32 v38, 0xc0135761, v38
    v_exp_f32 v38, v38
    s_nop 0
    v_add_f32 v38, 1.0, v38
    v_rcp_f32 v38, v38
    s_nop 0
    v_mul_f32 v38, v38, v36
    v_cvt_pk_bf16_f32 v38, v38, v38
    v_and_b32 v38, 0xffff0000, v38
    v_mul_f32 v38, v38, v37
    v_cvt_pk_bf16_f32 v52, v38, v38
L_nof2:
    ds_write_b32 v35, v52 offset:31392
    s_mov_b64 exec, 1
    ds_add_u32 v7, v12 offset:31256
    s_mov_b64 exec, -1
L_nofh:
    s_cmp_lg_u32 s4, 3
    s_cbranch_scc1 L_fdone
    s_lshr_b32 s43, s2, 4
    s_lshl_b32 s43, s43, 8
    s_add_u32 s43, s43, 0x5000
    v_mov_b32 v24, s43
    v_add_u32 v25, 0x2000, v24
    v_mov_b32 v28, s52
L_spin_35:
    ds_read_b32 v13, v7 offset:31252
    s_waitcnt lgkmcnt(0)
    v_readfirstlane_b32 s14, v13
    s_nop 0
    s_cmp_ge_u32 s14, 4
    s_cbranch_scc1 L_spind_36
    s_sleep 1
    s_sub_u32 s53, s53, 1
    s_cbranch_scc0 L_spin_35
    s_mov_b32 s53, 0
L_spind_36:
    s_mov_b64 exec, 1
    global_atomic_add v0, v24, v12, s[40:41] sc0 sc1
    s_cmp_lg_u32 s2, 0
    s_cbranch_scc1 L_nobump
    v_mov_b32 v14, 0
    global_store_dword v14, v28, s[40:41] sc1
L_nobump:
    s_waitcnt vmcnt(0)
    v_readfirstlane_b32 s14, v0
    s_nop 0
    s_sub_u32 s14, s14, s52
    s_cmp_lg_u32 s14, 15
    s_cbranch_scc1 L_fdone
    global_store_dword v25, v28, s[40:41] sc1
L_fdone:
L_end:
    s_endpgm
L_code_end:
.section .rodata,"a"
.p2align 6
.amdhsa_kernel recurrent_scan__compressed_kv_cla__geglu_ffn__decode_kernel
  .amdhsa_next_free_vgpr 256
  .amdhsa_next_free_sgpr 102
  .amdhsa_accum_offset 256
  .amdhsa_group_segment_fixed_size 0
  .amdhsa_kernarg_size 104
  .amdhsa_user_sgpr_count 2
  .amdhsa_user_sgpr_kernarg_segment_ptr 1
  .amdhsa_system_sgpr_workgroup_id_x 1
.end_amdhsa_kernel
```
